```python
import torch

def _softmax(x, axis=-1):
    return torch.softmax(x, dim=axis)
def _gelu(x):
    return torch.nn.functional.gelu(x, approximate="tanh")
def _silu(x):
    return torch.nn.functional.silu(x)
def _sigmoid(x):
    return torch.sigmoid(x)
def _layernorm(x, axis=-1, eps=1e-5):
    m = x.mean(dim=axis, keepdim=True)
    v = x.var(dim=axis, keepdim=True, unbiased=False)
    return (x - m) / torch.sqrt(v + eps)
def _scatter_add(tgt, idx, src, axis=0):
    return tgt.clone().index_add_(axis, idx, src)
def _segment_sum(src, seg, n):
    out = torch.zeros((n,) + src.shape[1:], dtype=src.dtype)
    return out.index_add_(0, seg, src)
def _pad(x, pw):
    flat = tuple(v for pair in reversed(pw) for v in pair)
    return torch.nn.functional.pad(x, flat)

kernel_name = 'standalone__mha_softmax__near_ridge'

def setup_inputs():

    _w = (lambda a: (lambda t: t.to(torch.bfloat16) if t.is_floating_point() else t)(torch.as_tensor(a)))
    B, H, Sq, Sk, D = 8, 32, 496, 512, 192
    return {
        "q": _w((lambda *s: torch.randn(*s, dtype=torch.bfloat16) * 0.8)(B, H, Sq, D)),
        "k": _w((lambda *s: torch.randn(*s, dtype=torch.bfloat16) * 0.8)(B, H, Sk, D)),
        "v": _w((lambda *s: torch.randn(*s, dtype=torch.bfloat16) * 0.05)(B, H, Sk, D)),
    }

def reference(q, k, v):
    scale = q.shape[-1] ** -0.5
    scores = torch.einsum("bhqd,bhkd->bhqk", q, k) * scale
    p = _softmax(scores, axis=-1)
    return torch.einsum("bhqk,bhkd->bhqd", p, v)
```

```asm
; @launch grid=(256,1,1) block=(256,1,1) lds=163840
.amdgcn_target "amdgcn-amd-amdhsa--gfx950"
.text
.globl standalone__mha_softmax__near_ridge_kernel
.p2align 8
.type standalone__mha_softmax__near_ridge_kernel,@function
standalone__mha_softmax__near_ridge_kernel:
    s_cmp_ge_u32 s2, 256
    s_cbranch_scc1 Lend
    s_load_dwordx4 s[84:87], s[0:1], 0
    s_load_dwordx4 s[88:91], s[0:1], 16
    s_and_b32 s34, s2, 7
    s_lshr_b32 s35, s2, 4
    s_lshl_b32 s35, s35, 3
    s_add_u32 s34, s34, s35
    s_bfe_u32 s36, s2, 0x10003
    v_lshrrev_b32 v40, 6, v0
    v_and_b32 v41, 63, v0
    v_readfirstlane_b32 s26, v40
    v_and_b32 v42, 15, v41
    v_lshrrev_b32 v43, 4, v41
    v_add_u32 v44, 0, v41
    v_mul_u32_u24 v45, 2731, v44
    v_lshrrev_b32 v45, 16, v45
    v_mul_u32_u24 v8, 24, v45
    v_sub_u32 v44, v44, v8
    v_and_b32 v8, 6, v45
    v_xor_b32 v44, v44, v8
    v_lshlrev_b32 v44, 4, v44
    v_lshl_add_u32 v45, v40, 3, v45
    v_mul_u32_u24 v45, 384, v45
    v_add_u32 v8, v44, v45
    v_add_u32 v44, 64, v41
    v_mul_u32_u24 v45, 2731, v44
    v_lshrrev_b32 v45, 16, v45
    v_mul_u32_u24 v9, 24, v45
    v_sub_u32 v44, v44, v9
    v_and_b32 v9, 6, v45
    v_xor_b32 v44, v44, v9
    v_lshlrev_b32 v44, 4, v44
    v_lshl_add_u32 v45, v40, 3, v45
    v_mul_u32_u24 v45, 384, v45
    v_add_u32 v9, v44, v45
    v_subrev_u32 v9, 1024, v9
    v_add_u32 v44, 128, v41
    v_mul_u32_u24 v45, 2731, v44
    v_lshrrev_b32 v45, 16, v45
    v_mul_u32_u24 v10, 24, v45
    v_sub_u32 v44, v44, v10
    v_and_b32 v10, 6, v45
    v_xor_b32 v44, v44, v10
    v_lshlrev_b32 v44, 4, v44
    v_lshl_add_u32 v45, v40, 3, v45
    v_mul_u32_u24 v45, 384, v45
    v_add_u32 v10, v44, v45
    v_subrev_u32 v10, 2048, v10
    v_lshrrev_b32 v44, 3, v41
    v_and_b32 v45, 7, v41
    v_mul_u32_u24 v12, 24576, v40
    v_mul_u32_u24 v13, 384, v44
    v_add_u32 v12, v12, v13
    v_and_b32 v13, 6, v44
    v_xor_b32 v13, v13, v45
    v_lshl_add_u32 v13, v13, 4, v12
    s_mul_i32 s97, s26, 3072
    s_add_u32 s22, s97, 49152
    s_mov_b32 s20, 0
    s_mov_b32 s21, 0
    s_mul_i32 s28, s36, 98304
    s_lshl_b32 s24, s26, 14
    s_add_u32 s24, s24, 98304
    s_lshl_b32 s38, s26, 13
    s_add_u32 s38, s38, 24576
    s_cmp_eq_u32 s26, 3
    s_cselect_b32 s38, 61440, s38
    s_mul_i32 s37, s34, 393216
    s_mul_i32 s35, s34, 380928
    s_getpc_b64 s[100:101]
    Lpc:
    s_lshr_b32 s3, s2, 3
    s_lshl_b32 s3, s3, 2
    s_add_u32 s3, s3, s26
    s_mul_i32 s96, s3, (65535+(Lhot_end-Lpc)/1024)/((Lhot_end-Lpc)/1024)
    s_lshr_b32 s96, s96, 16
    s_mul_i32 s96, s96, (Lhot_end-Lpc)/1024
    s_sub_u32 s3, s3, s96
    s_lshl_b32 s3, s3, 10
    s_add_u32 s100, s100, s3
    s_addc_u32 s101, s101, 0
    s_and_b32 s100, s100, -16
    v_lshlrev_b32 v6, 4, v41
    v_mov_b32 v7, s101
    v_add_co_u32 v6, vcc, s100, v6
    s_nop 1
    v_addc_co_u32 v7, vcc, 0, v7, vcc
    global_load_dwordx4 a[228:231], v[6:7], off
    s_waitcnt lgkmcnt(0)
    s_add_u32 s4, s86, s37
    s_addc_u32 s5, s87, 0
    s_mov_b32 s6, 393216
    s_mov_b32 s7, 0x20000
    s_add_u32 m0, s22, 0
    s_nop 0
    buffer_load_dwordx4 v8, s[4:7], s20 offen offset:0 nt lds
    buffer_load_dwordx4 v9, s[4:7], s20 offen offset:1024 nt lds
    buffer_load_dwordx4 v10, s[4:7], s20 offen offset:2048 nt lds
    s_add_u32 s20, s20, 12288
    s_add_u32 m0, s22, 24576
    s_nop 0
    buffer_load_dwordx4 v8, s[4:7], s20 offen offset:0 nt lds
    buffer_load_dwordx4 v9, s[4:7], s20 offen offset:1024 nt lds
    buffer_load_dwordx4 v10, s[4:7], s20 offen offset:2048 nt lds
    s_add_u32 s20, s20, 12288
    s_add_u32 s12, s84, s35
    s_addc_u32 s13, s85, 0
    s_mov_b32 s14, 190464
    s_mov_b32 s15, 0x20000
    s_add_u32 s8, s88, s37
    s_addc_u32 s9, s89, 0
    s_mov_b32 s10, 393216
    s_mov_b32 s11, 0x20000
    s_add_u32 s16, s90, s35
    s_addc_u32 s17, s91, 0
    s_mov_b32 s18, 190464
    s_mov_b32 s19, 0x20000
    s_add_u32 m0, s38, 0
    s_add_u32 s39, s28, 0
    buffer_load_dwordx4 v13, s[12:15], s39 offen offset:0 nt lds
    v_lshl_add_u32 v12, v45, 4, v12
    v_xor_b32 v17, v44, v45
    v_lshlrev_b32 v17, 4, v17
    v_lshl_add_u32 v17, v44, 7, v17
    v_add_u32 v17, s24, v17
    v_lshrrev_b32 v44, 1, v43
    v_and_b32 v45, 7, v42
    v_xor_b32 v44, v44, v45
    v_lshlrev_b32 v44, 4, v44
    v_and_b32 v45, 1, v43
    v_lshl_add_u32 v44, v45, 3, v44
    v_lshl_add_u32 v44, v42, 7, v44
    s_add_u32 m0, s38, 1024
    s_add_u32 s39, s28, 3072
    buffer_load_dwordx4 v13, s[12:15], s39 offen offset:0 nt lds
    v_add_u32 v16, s24, v44
    v_and_b32 v44, 6, v42
    v_xor_b32 v44, v44, v43
    v_lshlrev_b32 v44, 4, v44
    v_lshl_add_u32 v45, v42, 7, v44
    v_add_u32 v14, s24, v45
    v_xor_b32 v15, 64, v14
    v_add_u32 v30, s38, v45
    v_xor_b32 v31, 64, v30
    v_mul_u32_u24 v45, 384, v42
    v_add_u32 v44, v44, v45
    v_add_u32 v0, 0xc000, v44
    s_add_u32 m0, s38, 2048
    s_add_u32 s39, s28, 6144
    buffer_load_dwordx4 v13, s[12:15], s39 offen offset:0 nt lds
    v_xor_b32 v1, 64, v0
    v_mul_u32_u24 v44, 24576, v40
    v_add_u32 v44, v44, v45
    v_lshl_add_u32 v11, v43, 4, v44
    v_lshrrev_b32 v44, 2, v42
    v_lshl_add_u32 v45, v43, 2, v44
    v_mul_u32_u24 v45, 384, v45
    v_and_b32 v40, 3, v41
    v_lshl_add_u32 v45, v40, 3, v45
    v_lshrrev_b32 v44, 1, v44
    v_and_b32 v40, 1, v43
    v_lshl_add_u32 v44, v40, 1, v44
    s_add_u32 m0, s38, 3072
    s_add_u32 s39, s28, 9216
    buffer_load_dwordx4 v13, s[12:15], s39 offen offset:0 nt lds
    v_lshl_add_u32 v2, v44, 5, v45
    v_xor_b32 v3, 32, v2
    v_xor_b32 v4, 64, v2
    v_xor_b32 v5, 96, v2
    v_mov_b32 v128, 0
    v_mov_b32 v129, 0
    v_mov_b32 v130, 0
    v_mov_b32 v131, 0
    v_mov_b32 v132, 0
    v_mov_b32 v133, 0
    v_mov_b32 v134, 0
    v_mov_b32 v135, 0
    s_add_u32 m0, s38, 4096
    s_add_u32 s39, s28, 12288
    buffer_load_dwordx4 v13, s[12:15], s39 offen offset:0 nt lds
    v_mov_b32 v136, 0
    v_mov_b32 v137, 0
    v_mov_b32 v138, 0
    v_mov_b32 v139, 0
    v_mov_b32 v140, 0
    v_mov_b32 v141, 0
    v_mov_b32 v142, 0
    v_mov_b32 v143, 0
    v_mov_b32 v144, 0
    v_mov_b32 v145, 0
    v_mov_b32 v146, 0
    v_mov_b32 v147, 0
    s_add_u32 m0, s38, 5120
    s_add_u32 s39, s28, 15360
    buffer_load_dwordx4 v13, s[12:15], s39 offen offset:0 nt lds
    v_mov_b32 v148, 0
    v_mov_b32 v149, 0
    v_mov_b32 v150, 0
    v_mov_b32 v151, 0
    v_mov_b32 v152, 0
    v_mov_b32 v153, 0
    v_mov_b32 v154, 0
    v_mov_b32 v155, 0
    v_mov_b32 v156, 0
    v_mov_b32 v157, 0
    v_mov_b32 v158, 0
    v_mov_b32 v159, 0
    s_add_u32 m0, s38, 6144
    s_add_u32 s39, s28, 18432
    buffer_load_dwordx4 v13, s[12:15], s39 offen offset:0 nt lds
    v_mov_b32 v160, 0
    v_mov_b32 v161, 0
    v_mov_b32 v162, 0
    v_mov_b32 v163, 0
    v_mov_b32 v164, 0
    v_mov_b32 v165, 0
    v_mov_b32 v166, 0
    v_mov_b32 v167, 0
    v_mov_b32 v168, 0
    v_mov_b32 v169, 0
    v_mov_b32 v170, 0
    v_mov_b32 v171, 0
    s_add_u32 m0, s38, 7168
    s_add_u32 s39, s28, 21504
    buffer_load_dwordx4 v13, s[12:15], s39 offen offset:0 nt lds
    v_mov_b32 v172, 0
    v_mov_b32 v173, 0
    v_mov_b32 v174, 0
    v_mov_b32 v175, 0
    v_mov_b32 v176, 0
    v_mov_b32 v177, 0
    v_mov_b32 v178, 0
    v_mov_b32 v179, 0
    v_mov_b32 v180, 0
    v_mov_b32 v181, 0
    v_mov_b32 v182, 0
    v_mov_b32 v183, 0
    s_add_u32 m0, s24, 0
    s_add_u32 s39, s28, 128
    buffer_load_dwordx4 v13, s[12:15], s39 offen offset:0 nt lds
    v_mov_b32 v184, 0
    v_mov_b32 v185, 0
    v_mov_b32 v186, 0
    v_mov_b32 v187, 0
    v_mov_b32 v188, 0
    v_mov_b32 v189, 0
    v_mov_b32 v190, 0
    v_mov_b32 v191, 0
    v_mov_b32 v192, 0
    v_mov_b32 v193, 0
    v_mov_b32 v194, 0
    v_mov_b32 v195, 0
    s_add_u32 m0, s24, 1024
    s_add_u32 s39, s28, 3200
    buffer_load_dwordx4 v13, s[12:15], s39 offen offset:0 nt lds
    v_mov_b32 v196, 0
    v_mov_b32 v197, 0
    v_mov_b32 v198, 0
    v_mov_b32 v199, 0
    v_mov_b32 v200, 0
    v_mov_b32 v201, 0
    v_mov_b32 v202, 0
    v_mov_b32 v203, 0
    v_mov_b32 v204, 0
    v_mov_b32 v205, 0
    v_mov_b32 v206, 0
    v_mov_b32 v207, 0
    s_add_u32 m0, s24, 2048
    s_add_u32 s39, s28, 6272
    buffer_load_dwordx4 v13, s[12:15], s39 offen offset:0 nt lds
    v_mov_b32 v208, 0
    v_mov_b32 v209, 0
    v_mov_b32 v210, 0
    v_mov_b32 v211, 0
    v_mov_b32 v212, 0
    v_mov_b32 v213, 0
    v_mov_b32 v214, 0
    v_mov_b32 v215, 0
    v_mov_b32 v216, 0
    v_mov_b32 v217, 0
    v_mov_b32 v218, 0
    v_mov_b32 v219, 0
    s_add_u32 m0, s24, 3072
    s_add_u32 s39, s28, 9344
    buffer_load_dwordx4 v13, s[12:15], s39 offen offset:0 nt lds
    v_mov_b32 v220, 0
    v_mov_b32 v221, 0
    v_mov_b32 v222, 0
    v_mov_b32 v223, 0
    v_mov_b32 v224, 0
    v_mov_b32 v225, 0
    v_mov_b32 v226, 0
    v_mov_b32 v227, 0
    v_mov_b32 v228, 0
    v_mov_b32 v229, 0
    v_mov_b32 v230, 0
    v_mov_b32 v231, 0
    s_add_u32 m0, s24, 4096
    s_add_u32 s39, s28, 12416
    buffer_load_dwordx4 v13, s[12:15], s39 offen offset:0 nt lds
    v_mov_b32 v232, 0
    v_mov_b32 v233, 0
    v_mov_b32 v234, 0
    v_mov_b32 v235, 0
    v_mov_b32 v236, 0
    v_mov_b32 v237, 0
    v_mov_b32 v238, 0
    v_mov_b32 v239, 0
    v_mov_b32 v240, 0
    v_mov_b32 v241, 0
    v_mov_b32 v242, 0
    v_mov_b32 v243, 0
    s_add_u32 m0, s24, 5120
    s_add_u32 s39, s28, 15488
    buffer_load_dwordx4 v13, s[12:15], s39 offen offset:0 nt lds
    v_mov_b32 v244, 0
    v_mov_b32 v245, 0
    v_mov_b32 v246, 0
    v_mov_b32 v247, 0
    v_mov_b32 v248, 0
    v_mov_b32 v249, 0
    v_mov_b32 v250, 0
    v_mov_b32 v251, 0
    v_mov_b32 v252, 0
    v_mov_b32 v253, 0
    v_mov_b32 v254, 0
    v_mov_b32 v255, 0
    s_add_u32 m0, s24, 6144
    s_add_u32 s39, s28, 18560
    buffer_load_dwordx4 v13, s[12:15], s39 offen offset:0 nt lds
    v_accvgpr_write_b32 a152, 0
    v_accvgpr_write_b32 a153, 0
    v_accvgpr_write_b32 a154, 0
    v_accvgpr_write_b32 a155, 0
    v_accvgpr_write_b32 a156, 0
    v_accvgpr_write_b32 a157, 0
    v_accvgpr_write_b32 a158, 0
    v_accvgpr_write_b32 a159, 0
    v_accvgpr_write_b32 a160, 0
    v_accvgpr_write_b32 a161, 0
    v_accvgpr_write_b32 a162, 0
    v_accvgpr_write_b32 a163, 0
    s_add_u32 m0, s24, 7168
    s_add_u32 s39, s28, 21632
    buffer_load_dwordx4 v13, s[12:15], s39 offen offset:0 nt lds
    v_accvgpr_write_b32 a164, 0
    v_accvgpr_write_b32 a165, 0
    v_accvgpr_write_b32 a166, 0
    v_accvgpr_write_b32 a167, 0
    v_accvgpr_write_b32 a168, 0
    v_accvgpr_write_b32 a169, 0
    v_accvgpr_write_b32 a170, 0
    v_accvgpr_write_b32 a171, 0
    v_accvgpr_write_b32 a172, 0
    v_accvgpr_write_b32 a173, 0
    v_accvgpr_write_b32 a174, 0
    v_accvgpr_write_b32 a175, 0
    s_add_u32 m0, s24, 8192
    s_add_u32 s39, s28, 256
    buffer_load_dwordx4 v13, s[12:15], s39 offen offset:0 nt lds
    v_accvgpr_write_b32 a176, 0
    v_accvgpr_write_b32 a177, 0
    v_accvgpr_write_b32 a178, 0
    v_accvgpr_write_b32 a179, 0
    v_accvgpr_write_b32 a180, 0
    v_accvgpr_write_b32 a181, 0
    v_accvgpr_write_b32 a182, 0
    v_accvgpr_write_b32 a183, 0
    v_accvgpr_write_b32 a184, 0
    v_accvgpr_write_b32 a185, 0
    v_accvgpr_write_b32 a186, 0
    v_accvgpr_write_b32 a187, 0
    s_add_u32 m0, s24, 9216
    s_add_u32 s39, s28, 3328
    buffer_load_dwordx4 v13, s[12:15], s39 offen offset:0 nt lds
    v_accvgpr_write_b32 a188, 0
    v_accvgpr_write_b32 a189, 0
    v_accvgpr_write_b32 a190, 0
    v_accvgpr_write_b32 a191, 0
    v_accvgpr_write_b32 a192, 0
    v_accvgpr_write_b32 a193, 0
    v_accvgpr_write_b32 a194, 0
    v_accvgpr_write_b32 a195, 0
    v_accvgpr_write_b32 a196, 0
    v_accvgpr_write_b32 a197, 0
    v_accvgpr_write_b32 a198, 0
    v_accvgpr_write_b32 a199, 0
    s_add_u32 m0, s24, 10240
    s_add_u32 s39, s28, 6400
    buffer_load_dwordx4 v13, s[12:15], s39 offen offset:0 nt lds
    v_accvgpr_write_b32 a200, 0
    v_accvgpr_write_b32 a201, 0
    v_accvgpr_write_b32 a202, 0
    v_accvgpr_write_b32 a203, 0
    v_accvgpr_write_b32 a204, 0
    v_accvgpr_write_b32 a205, 0
    v_accvgpr_write_b32 a206, 0
    v_accvgpr_write_b32 a207, 0
    v_accvgpr_write_b32 a208, 0
    v_accvgpr_write_b32 a209, 0
    v_accvgpr_write_b32 a210, 0
    v_accvgpr_write_b32 a211, 0
    s_add_u32 m0, s24, 11264
    s_add_u32 s39, s28, 9472
    buffer_load_dwordx4 v13, s[12:15], s39 offen offset:0 nt lds
    v_accvgpr_write_b32 a212, 0
    v_accvgpr_write_b32 a213, 0
    v_accvgpr_write_b32 a214, 0
    v_accvgpr_write_b32 a215, 0
    s_add_u32 s29, s28, 6144
    s_add_u32 s30, s28, 12288
    s_add_u32 s31, s28, 18432
    s_mov_b32 s38, s24
    s_mov_b32 s39, s28
    s_mov_b32 s23, 0x3dd53b95
    s_mov_b32 s25, 0
    s_mov_b32 s98, 1024
    s_waitcnt vmcnt(12)
    ds_read_b128 a[0:3], v30 offset:0
    ds_read_b128 a[4:7], v31 offset:0
    ds_read_b128 a[8:11], v30 offset:2048
    ds_read_b128 a[12:15], v31 offset:2048
    ds_read_b128 a[16:19], v30 offset:4096
    ds_read_b128 a[20:23], v31 offset:4096
    ds_read_b128 a[24:27], v30 offset:6144
    ds_read_b128 a[28:31], v31 offset:6144
    s_waitcnt lgkmcnt(0)
    s_barrier
    ds_read_b128 a[128:131], v0 offset:0
    ds_read_b128 a[132:135], v1 offset:0
    ds_read_b128 a[136:139], v0 offset:6144
    ds_read_b128 a[140:143], v1 offset:6144
    ds_read_b128 a[144:147], v0 offset:24576
    ds_read_b128 a[148:151], v1 offset:24576
    s_waitcnt lgkmcnt(5)
    v_mfma_f32_16x16x32_bf16 v[64:67], a[128:131], a[0:3], 0
    s_waitcnt lgkmcnt(4)
    v_mfma_f32_16x16x32_bf16 v[64:67], a[132:135], a[4:7], v[64:67]
    s_add_u32 m0, s24, 12288
    v_mfma_f32_16x16x32_bf16 v[72:75], a[128:131], a[8:11], 0
    s_add_u32 s27, s28, 12544
    buffer_load_dwordx4 v13, s[12:15], s27 offen offset:0 nt lds
    v_mfma_f32_16x16x32_bf16 v[72:75], a[132:135], a[12:15], v[72:75]
    s_add_u32 m0, s24, 13312
    v_mfma_f32_16x16x32_bf16 v[80:83], a[128:131], a[16:19], 0
    s_add_u32 s27, s28, 15616
    v_mfma_f32_16x16x32_bf16 v[80:83], a[132:135], a[20:23], v[80:83]
    buffer_load_dwordx4 v13, s[12:15], s27 offen offset:0 nt lds
    v_mfma_f32_16x16x32_bf16 v[88:91], a[128:131], a[24:27], 0
    s_add_u32 m0, s24, 14336
    ds_read_b128 a[128:131], v0 offset:30720
    v_mfma_f32_16x16x32_bf16 v[88:91], a[132:135], a[28:31], v[88:91]
    s_waitcnt lgkmcnt(4)
    ds_read_b128 a[132:135], v1 offset:30720
    v_mfma_f32_16x16x32_bf16 v[68:71], a[136:139], a[0:3], 0
    s_waitcnt lgkmcnt(4)
    v_mfma_f32_16x16x32_bf16 v[68:71], a[140:143], a[4:7], v[68:71]
    s_add_u32 s27, s28, 18688
    buffer_load_dwordx4 v13, s[12:15], s27 offen offset:0 nt lds
    v_mfma_f32_16x16x32_bf16 v[76:79], a[136:139], a[8:11], 0
    s_add_u32 m0, s24, 15360
    v_mfma_f32_16x16x32_bf16 v[76:79], a[140:143], a[12:15], v[76:79]
    s_add_u32 s27, s28, 21760
    buffer_load_dwordx4 v13, s[12:15], s27 offen offset:0 nt lds
    v_mfma_f32_16x16x32_bf16 v[84:87], a[136:139], a[16:19], 0
    s_add_u32 s12, s12, 190464
    v_mfma_f32_16x16x32_bf16 v[84:87], a[140:143], a[20:23], v[84:87]
    s_addc_u32 s13, s13, 0
    v_mfma_f32_16x16x32_bf16 v[92:95], a[136:139], a[24:27], 0
    s_mov_b32 s27, s28
    ds_read_b128 a[136:139], v0 offset:128
    v_mfma_f32_16x16x32_bf16 v[92:95], a[140:143], a[28:31], v[92:95]
    s_waitcnt lgkmcnt(4)
    ds_read_b128 a[140:143], v1 offset:128
    v_mfma_f32_16x16x32_bf16 v[96:99], a[144:147], a[0:3], 0
    s_waitcnt lgkmcnt(4)
    v_mfma_f32_16x16x32_bf16 v[96:99], a[148:151], a[4:7], v[96:99]
    s_xor_b32 s22, s22, 0xc000
    v_mfma_f32_16x16x32_bf16 v[104:107], a[144:147], a[8:11], 0
    s_add_u32 m0, s22, 0
    v_mfma_f32_16x16x32_bf16 v[104:107], a[148:151], a[12:15], v[104:107]
    buffer_load_dwordx4 v8, s[4:7], s20 offen offset:0 nt lds
    buffer_load_dwordx4 v9, s[4:7], s20 offen offset:1024 nt lds
    v_mfma_f32_16x16x32_bf16 v[112:115], a[144:147], a[16:19], 0
    s_waitcnt vmcnt(16)
    buffer_load_dwordx4 v10, s[4:7], s20 offen offset:2048 nt lds
    ds_read_b128 a[32:35], v14 offset:0
    v_mfma_f32_16x16x32_bf16 v[112:115], a[148:151], a[20:23], v[112:115]
    s_add_u32 s20, s20, 12288
    ds_read_b128 a[36:39], v15 offset:0
    v_mfma_f32_16x16x32_bf16 v[120:123], a[144:147], a[24:27], 0
    s_add_u32 m0, s22, 12288
    ds_read_b128 a[144:147], v0 offset:6272
    buffer_load_dwordx4 v8, s[8:11], s21 offen offset:0 nt lds
    v_mfma_f32_16x16x32_bf16 v[120:123], a[148:151], a[28:31], v[120:123]
    s_waitcnt lgkmcnt(6)
    ds_read_b128 a[148:151], v1 offset:6272
    v_mfma_f32_16x16x32_bf16 v[100:103], a[128:131], a[0:3], 0
    s_waitcnt lgkmcnt(6)
    buffer_load_dwordx4 v9, s[8:11], s21 offen offset:1024 nt lds
    v_mfma_f32_16x16x32_bf16 v[100:103], a[132:135], a[4:7], v[100:103]
    s_waitcnt vmcnt(17)
    ds_read_b128 a[40:43], v14 offset:2048
    ds_read_b128 a[44:47], v15 offset:2048
    v_mfma_f32_16x16x32_bf16 v[108:111], a[128:131], a[8:11], 0
    s_waitcnt vmcnt(15)
    ds_read_b128 a[48:51], v14 offset:4096
    ds_read_b128 a[52:55], v15 offset:4096
    v_mfma_f32_16x16x32_bf16 v[108:111], a[132:135], a[12:15], v[108:111]
    s_waitcnt vmcnt(13)
    buffer_load_dwordx4 v10, s[8:11], s21 offen offset:2048 nt lds
    ds_read_b128 a[56:59], v14 offset:6144
    v_mfma_f32_16x16x32_bf16 v[116:119], a[128:131], a[16:19], 0
    s_add_u32 s21, s21, 12288
    ds_read_b128 a[60:63], v15 offset:6144
    v_mfma_f32_16x16x32_bf16 v[116:119], a[132:135], a[20:23], v[116:119]
    s_add_u32 m0, s22, 24576
    v_mfma_f32_16x16x32_bf16 v[124:127], a[128:131], a[24:27], 0
    buffer_load_dwordx4 v8, s[4:7], s20 offen offset:0 nt lds
    ds_read_b128 a[128:131], v0 offset:24704
    v_mfma_f32_16x16x32_bf16 v[124:127], a[132:135], a[28:31], v[124:127]
    s_waitcnt lgkmcnt(10)
    buffer_load_dwordx4 v9, s[4:7], s20 offen offset:1024 nt lds
    ds_read_b128 a[132:135], v1 offset:24704
    v_mfma_f32_16x16x32_bf16 v[64:67], a[136:139], a[32:35], v[64:67]
    s_waitcnt lgkmcnt(10)
    v_mfma_f32_16x16x32_bf16 v[64:67], a[140:143], a[36:39], v[64:67]
    s_waitcnt lgkmcnt(7)
    buffer_load_dwordx4 v10, s[4:7], s20 offen offset:2048 nt lds
    v_mfma_f32_16x16x32_bf16 v[72:75], a[136:139], a[40:43], v[72:75]
    s_waitcnt lgkmcnt(6)
    v_mfma_f32_16x16x32_bf16 v[72:75], a[140:143], a[44:47], v[72:75]
    s_waitcnt lgkmcnt(5)
    v_mfma_f32_16x16x32_bf16 v[80:83], a[136:139], a[48:51], v[80:83]
    s_waitcnt lgkmcnt(4)
    v_mfma_f32_16x16x32_bf16 v[80:83], a[140:143], a[52:55], v[80:83]
    s_waitcnt lgkmcnt(3)
    v_mfma_f32_16x16x32_bf16 v[88:91], a[136:139], a[56:59], v[88:91]
    s_waitcnt lgkmcnt(2)
    ds_read_b128 a[136:139], v0 offset:30848
    s_add_u32 s20, s20, 12288
    v_mfma_f32_16x16x32_bf16 v[88:91], a[140:143], a[60:63], v[88:91]
    s_add_u32 m0, s22, 36864
    ds_read_b128 a[140:143], v1 offset:30848
    buffer_load_dwordx4 v8, s[8:11], s21 offen offset:0 nt lds
    v_mfma_f32_16x16x32_bf16 v[68:71], a[144:147], a[32:35], v[68:71]
    buffer_load_dwordx4 v9, s[8:11], s21 offen offset:1024 nt lds
    buffer_load_dwordx4 v10, s[8:11], s21 offen offset:2048 nt lds
    v_mfma_f32_16x16x32_bf16 v[68:71], a[148:151], a[36:39], v[68:71]
    s_add_u32 s21, s21, 12288
    v_mfma_f32_16x16x32_bf16 v[76:79], a[144:147], a[40:43], v[76:79]
    v_mfma_f32_16x16x32_bf16 v[76:79], a[148:151], a[44:47], v[76:79]
    s_xor_b32 s22, s22, 0xc000
    global_load_dwordx4 a[228:231], v[6:7], off
    v_mfma_f32_16x16x32_bf16 v[84:87], a[144:147], a[48:51], v[84:87]
    v_mfma_f32_16x16x32_bf16 v[84:87], a[148:151], a[52:55], v[84:87]
    v_mfma_f32_16x16x32_bf16 v[92:95], a[144:147], a[56:59], v[92:95]
    ds_read_b128 a[144:147], v0 offset:256
    v_mfma_f32_16x16x32_bf16 v[92:95], a[148:151], a[60:63], v[92:95]
    s_waitcnt lgkmcnt(4)
    ds_read_b128 a[148:151], v1 offset:256
    v_mfma_f32_16x16x32_bf16 v[96:99], a[128:131], a[32:35], v[96:99]
    s_waitcnt lgkmcnt(4)
    v_mfma_f32_16x16x32_bf16 v[96:99], a[132:135], a[36:39], v[96:99]
    v_mfma_f32_16x16x32_bf16 v[104:107], a[128:131], a[40:43], v[104:107]
    v_mfma_f32_16x16x32_bf16 v[104:107], a[132:135], a[44:47], v[104:107]
    v_mfma_f32_16x16x32_bf16 v[112:115], a[128:131], a[48:51], v[112:115]
    s_waitcnt vmcnt(19)
    ds_read_b128 a[64:67], v14 offset:8192
    ds_read_b128 a[68:71], v15 offset:8192
    v_mfma_f32_16x16x32_bf16 v[112:115], a[132:135], a[52:55], v[112:115]
    v_mfma_f32_16x16x32_bf16 v[120:123], a[128:131], a[56:59], v[120:123]
    s_waitcnt vmcnt(17)
    ds_read_b128 a[128:131], v0 offset:6400
    ds_read_b128 a[72:75], v14 offset:10240
    v_mfma_f32_16x16x32_bf16 v[120:123], a[132:135], a[60:63], v[120:123]
    s_waitcnt lgkmcnt(7)
    ds_read_b128 a[76:79], v15 offset:10240
    ds_read_b128 a[132:135], v1 offset:6400
    v_mfma_f32_16x16x32_bf16 v[100:103], a[136:139], a[32:35], v[100:103]
    s_waitcnt lgkmcnt(8)
    v_mfma_f32_16x16x32_bf16 v[100:103], a[140:143], a[36:39], v[100:103]
    s_waitcnt vmcnt(15)
    ds_read_b128 a[80:83], v14 offset:12288
    ds_read_b128 a[84:87], v15 offset:12288
    v_mfma_f32_16x16x32_bf16 v[108:111], a[136:139], a[40:43], v[108:111]
    s_waitcnt vmcnt(13)
    ds_read_b128 a[88:91], v14 offset:14336
    ds_read_b128 a[92:95], v15 offset:14336
    v_mfma_f32_16x16x32_bf16 v[108:111], a[140:143], a[44:47], v[108:111]
    v_mfma_f32_16x16x32_bf16 v[116:119], a[136:139], a[48:51], v[116:119]
    v_mfma_f32_16x16x32_bf16 v[116:119], a[140:143], a[52:55], v[116:119]
    v_mfma_f32_16x16x32_bf16 v[124:127], a[136:139], a[56:59], v[124:127]
    ds_read_b128 a[136:139], v0 offset:24832
    v_mfma_f32_16x16x32_bf16 v[124:127], a[140:143], a[60:63], v[124:127]
    s_waitcnt lgkmcnt(10)
    ds_read_b128 a[140:143], v1 offset:24832
    v_mfma_f32_16x16x32_bf16 v[64:67], a[144:147], a[64:67], v[64:67]
    s_waitcnt lgkmcnt(10)
    v_mfma_f32_16x16x32_bf16 v[64:67], a[148:151], a[68:71], v[64:67]
    s_waitcnt lgkmcnt(8)
    v_mfma_f32_16x16x32_bf16 v[72:75], a[144:147], a[72:75], v[72:75]
    s_waitcnt lgkmcnt(7)
    v_mfma_f32_16x16x32_bf16 v[72:75], a[148:151], a[76:79], v[72:75]
    s_waitcnt lgkmcnt(5)
    v_mfma_f32_16x16x32_bf16 v[80:83], a[144:147], a[80:83], v[80:83]
    s_waitcnt lgkmcnt(4)
    v_mfma_f32_16x16x32_bf16 v[80:83], a[148:151], a[84:87], v[80:83]
    s_waitcnt lgkmcnt(3)
    v_mfma_f32_16x16x32_bf16 v[88:91], a[144:147], a[88:91], v[88:91]
    s_waitcnt lgkmcnt(2)
    ds_read_b128 a[144:147], v0 offset:30976
    v_xor_b32 v0, 0xc000, v0
    v_mfma_f32_16x16x32_bf16 v[88:91], a[148:151], a[92:95], v[88:91]
    ds_read_b128 a[148:151], v1 offset:30976
    v_xor_b32 v1, 0xc000, v1
    v_mfma_f32_16x16x32_bf16 v[68:71], a[128:131], a[64:67], v[68:71]
    v_mfma_f32_16x16x32_bf16 v[68:71], a[132:135], a[68:71], v[68:71]
    v_mfma_f32_16x16x32_bf16 v[76:79], a[128:131], a[72:75], v[76:79]
    v_mfma_f32_16x16x32_bf16 v[76:79], a[132:135], a[76:79], v[76:79]
    v_mfma_f32_16x16x32_bf16 v[84:87], a[128:131], a[80:83], v[84:87]
    v_mfma_f32_16x16x32_bf16 v[84:87], a[132:135], a[84:87], v[84:87]
    s_waitcnt vmcnt(7) lgkmcnt(0)
    v_mfma_f32_16x16x32_bf16 v[92:95], a[128:131], a[88:91], v[92:95]
    s_barrier
    ds_read_b64_tr_b16 a[128:129], v2 offset:12288
    ds_read_b64_tr_b16 a[130:131], v2 offset:18432
    v_mfma_f32_16x16x32_bf16 v[92:95], a[132:135], a[92:95], v[92:95]
    s_add_u32 m0, s22, 0
    ds_read_b64_tr_b16 a[132:133], v3 offset:12288
    ds_read_b64_tr_b16 a[134:135], v3 offset:18432
    v_mfma_f32_16x16x32_bf16 v[96:99], a[136:139], a[64:67], v[96:99]
    buffer_load_dwordx4 v8, s[4:7], s20 offen offset:0 nt lds
    v_mfma_f32_16x16x32_bf16 v[96:99], a[140:143], a[68:71], v[96:99]
    buffer_load_dwordx4 v9, s[4:7], s20 offen offset:1024 nt lds
    v_max3_f32 v18, v64, v65, v66
    v_max3_f32 v19, v72, v73, v74
    v_max3_f32 v20, v80, v81, v82
    v_max3_f32 v21, v88, v89, v90
    v_mfma_f32_16x16x32_bf16 v[104:107], a[136:139], a[72:75], v[104:107]
    buffer_load_dwordx4 v10, s[4:7], s20 offen offset:2048 nt lds
    v_max3_f32 v18, v18, v67, v68
    v_max3_f32 v19, v19, v75, v76
    v_max3_f32 v20, v20, v83, v84
    v_mfma_f32_16x16x32_bf16 v[104:107], a[140:143], a[76:79], v[104:107]
    s_add_u32 s20, s20, 12288
    v_max3_f32 v21, v21, v91, v92
    v_max3_f32 v18, v18, v69, v70
    v_max3_f32 v19, v19, v77, v78
    v_max3_f32 v20, v20, v85, v86
    v_mfma_f32_16x16x32_bf16 v[112:115], a[136:139], a[80:83], v[112:115]
    s_add_u32 m0, s22, 12288
    v_max3_f32 v21, v21, v93, v94
    v_max_f32 v18, v18, v71
    v_max_f32 v19, v19, v79
    v_mfma_f32_16x16x32_bf16 v[112:115], a[140:143], a[84:87], v[112:115]
    buffer_load_dwordx4 v8, s[8:11], s21 offen offset:0 nt lds
    v_max_f32 v20, v20, v87
    v_max_f32 v21, v21, v95
    v_mov_b32 v34, v18
    v_mfma_f32_16x16x32_bf16 v[120:123], a[136:139], a[88:91], v[120:123]
    ds_read_b64_tr_b16 a[136:137], v4 offset:12288
    ds_read_b64_tr_b16 a[138:139], v4 offset:18432
    buffer_load_dwordx4 v9, s[8:11], s21 offen offset:1024 nt lds
    v_mov_b32 v35, v19
    v_mov_b32 v36, v20
    v_mov_b32 v37, v21
    v_permlane32_swap_b32 v34, v18
    v_mfma_f32_16x16x32_bf16 v[120:123], a[140:143], a[92:95], v[120:123]
    ds_read_b64_tr_b16 a[140:141], v5 offset:12288
    ds_read_b64_tr_b16 a[142:143], v5 offset:18432
    buffer_load_dwordx4 v10, s[8:11], s21 offen offset:2048 nt lds
    v_permlane32_swap_b32 v35, v19
    v_permlane32_swap_b32 v36, v20
    v_permlane32_swap_b32 v37, v21
    v_mfma_f32_16x16x32_bf16 v[100:103], a[144:147], a[64:67], v[100:103]
    s_add_u32 s21, s21, 12288
    v_max_f32 v18, v18, v34
    v_max_f32 v19, v19, v35
    v_max_f32 v20, v20, v36
    v_mfma_f32_16x16x32_bf16 v[100:103], a[148:151], a[68:71], v[100:103]
    s_add_u32 m0, s22, 24576
    v_max_f32 v21, v21, v37
    v_mov_b32 v34, v18
    v_mov_b32 v35, v19
    v_mov_b32 v36, v20
    v_mfma_f32_16x16x32_bf16 v[108:111], a[144:147], a[72:75], v[108:111]
    buffer_load_dwordx4 v8, s[4:7], s20 offen offset:0 nt lds
    v_mov_b32 v37, v21
    v_permlane16_swap_b32 v34, v18
    v_permlane16_swap_b32 v35, v19
    v_mfma_f32_16x16x32_bf16 v[108:111], a[148:151], a[76:79], v[108:111]
    buffer_load_dwordx4 v9, s[4:7], s20 offen offset:1024 nt lds
    v_permlane16_swap_b32 v36, v20
    v_permlane16_swap_b32 v37, v21
    v_max_f32 v18, v18, v34
    v_mfma_f32_16x16x32_bf16 v[116:119], a[144:147], a[80:83], v[116:119]
    buffer_load_dwordx4 v10, s[4:7], s20 offen offset:2048 nt lds
    v_max_f32 v19, v19, v35
    v_max_f32 v20, v20, v36
    v_max_f32 v21, v21, v37
    v_mul_f32 v18, s23, v18
    v_mfma_f32_16x16x32_bf16 v[116:119], a[148:151], a[84:87], v[116:119]
    s_waitcnt lgkmcnt(6)
    v_mul_f32 v19, s23, v19
    v_mul_f32 v20, s23, v20
    v_mul_f32 v21, s23, v21
    v_mfma_f32_16x16x32_bf16 v[124:127], a[144:147], a[88:91], v[124:127]
    s_add_u32 s20, s20, 12288
    v_fma_f32 v64, v64, s23, -v18
    v_fma_f32 v65, v65, s23, -v18
    v_fma_f32 v66, v66, s23, -v18
    v_mfma_f32_16x16x32_bf16 v[124:127], a[148:151], a[92:95], v[124:127]
    v_fma_f32 v67, v67, s23, -v18
    v_exp_f32 v34, v64
    v_fma_f32 v68, v68, s23, -v18
    v_exp_f32 v35, v65
    v_fma_f32 v69, v69, s23, -v18
    s_mov_b32 m0, s38
    v_exp_f32 v36, v66
    v_fma_f32 v70, v70, s23, -v18
    v_add_f32 v22, v34, v35
    v_cvt_pk_bf16_f32 v40, v34, v35
    v_exp_f32 v37, v67
    buffer_load_dwordx4 v13, s[12:15], s39 offen offset:0 nt lds
    v_fma_f32 v71, v71, s23, -v18
    v_add_f32 v22, v22, v36
    v_exp_f32 v34, v68
    v_fma_f32 v72, v72, s23, -v19
    v_add_f32 v22, v22, v37
    v_cvt_pk_bf16_f32 v41, v36, v37
    v_exp_f32 v35, v69
    v_fma_f32 v73, v73, s23, -v19
    v_add_f32 v22, v22, v34
    v_exp_f32 v36, v70
    v_fma_f32 v74, v74, s23, -v19
    v_add_f32 v22, v22, v35
    v_cvt_pk_bf16_f32 v42, v34, v35
    v_exp_f32 v37, v71
    v_fma_f32 v75, v75, s23, -v19
    v_add_f32 v22, v22, v36
    v_add_f32 v22, v22, v37
    v_cvt_pk_bf16_f32 v43, v36, v37
    v_exp_f32 v34, v72
    v_fma_f32 v76, v76, s23, -v19
    v_exp_f32 v35, v73
    s_add_u32 m0, s38, 8064
    v_fma_f32 v77, v77, s23, -v19
    v_exp_f32 v36, v74
    v_fma_f32 v78, v78, s23, -v19
    v_add_f32 v23, v34, v35
    v_cvt_pk_bf16_f32 v44, v34, v35
    buffer_load_dwordx4 v13, s[12:15], s39 offen offset:128 nt lds
    v_exp_f32 v37, v75
    v_fma_f32 v79, v79, s23, -v19
    v_add_f32 v23, v23, v36
    s_add_u32 s38, s38, 1024
    v_exp_f32 v34, v76
    v_fma_f32 v80, v80, s23, -v20
    s_add_u32 s39, s39, 3072
    v_add_f32 v23, v23, v37
    v_cvt_pk_bf16_f32 v45, v36, v37
    v_exp_f32 v35, v77
    v_fma_f32 v81, v81, s23, -v20
    v_add_f32 v23, v23, v34
    v_exp_f32 v36, v78
    v_fma_f32 v82, v82, s23, -v20
    v_add_f32 v23, v23, v35
    v_cvt_pk_bf16_f32 v46, v34, v35
    v_exp_f32 v37, v79
    v_fma_f32 v83, v83, s23, -v20
    v_add_f32 v23, v23, v36
    v_add_f32 v23, v23, v37
    v_cvt_pk_bf16_f32 v47, v36, v37
    v_exp_f32 v34, v80
    v_fma_f32 v84, v84, s23, -v20
    v_exp_f32 v35, v81
    v_fma_f32 v85, v85, s23, -v20
    v_exp_f32 v36, v82
    v_fma_f32 v86, v86, s23, -v20
    v_add_f32 v24, v34, v35
    v_cvt_pk_bf16_f32 v56, v34, v35
    v_exp_f32 v37, v83
    v_fma_f32 v87, v87, s23, -v20
    v_add_f32 v24, v24, v36
    v_exp_f32 v34, v84
    v_fma_f32 v88, v88, s23, -v21
    v_add_f32 v24, v24, v37
    v_cvt_pk_bf16_f32 v57, v36, v37
    v_exp_f32 v35, v85
    v_fma_f32 v89, v89, s23, -v21
    v_add_f32 v24, v24, v34
    v_exp_f32 v36, v86
    v_fma_f32 v90, v90, s23, -v21
    v_add_f32 v24, v24, v35
    v_cvt_pk_bf16_f32 v58, v34, v35
    v_exp_f32 v37, v87
    v_fma_f32 v91, v91, s23, -v21
    v_add_f32 v24, v24, v36
    v_add_f32 v24, v24, v37
    v_cvt_pk_bf16_f32 v59, v36, v37
    v_exp_f32 v34, v88
    v_fma_f32 v92, v92, s23, -v21
    v_exp_f32 v35, v89
    v_fma_f32 v93, v93, s23, -v21
    v_exp_f32 v36, v90
    v_fma_f32 v94, v94, s23, -v21
    v_add_f32 v25, v34, v35
    v_cvt_pk_bf16_f32 v60, v34, v35
    v_exp_f32 v37, v91
    v_fma_f32 v95, v95, s23, -v21
    v_add_f32 v25, v25, v36
    v_exp_f32 v34, v92
    v_add_f32 v25, v25, v37
    v_cvt_pk_bf16_f32 v61, v36, v37
    v_exp_f32 v35, v93
    v_add_f32 v25, v25, v34
    v_exp_f32 v36, v94
    v_add_f32 v25, v25, v35
    v_cvt_pk_bf16_f32 v62, v34, v35
    v_exp_f32 v37, v95
    v_add_f32 v25, v25, v36
    v_add_f32 v25, v25, v37
    v_cvt_pk_bf16_f32 v63, v36, v37
Lloop1:
    v_mfma_f32_16x16x32_bf16 v[128:131], a[128:131], v[40:43], v[128:131]
    ds_read_b64_tr_b16 a[144:145], v2 offset:12416
    ds_read_b64_tr_b16 a[146:147], v2 offset:18560
    v_mfma_f32_16x16x32_bf16 v[132:135], a[128:131], v[44:47], v[132:135]
    s_add_u32 m0, s22, 36864
    ds_read_b64_tr_b16 a[148:149], v3 offset:12416
    ds_read_b64_tr_b16 a[150:151], v3 offset:18560
    v_mfma_f32_16x16x32_bf16 v[136:139], a[128:131], v[56:59], v[136:139]
    buffer_load_dwordx4 v8, s[8:11], s21 offen offset:0 nt lds
    v_fma_f32 v96, v96, s23, -v18
    v_mfma_f32_16x16x32_bf16 v[140:143], a[128:131], v[60:63], v[140:143]
    s_waitcnt lgkmcnt(8)
    ds_read_b64_tr_b16 a[128:129], v4 offset:12416
    ds_read_b64_tr_b16 a[130:131], v4 offset:18560
    v_mfma_f32_16x16x32_bf16 v[156:159], a[132:135], v[60:63], v[156:159]
    v_fma_f32 v97, v97, s23, -v18
    v_fma_f32 v98, v98, s23, -v18
    v_mfma_f32_16x16x32_bf16 v[152:155], a[132:135], v[56:59], v[152:155]
    v_fma_f32 v99, v99, s23, -v18
    v_fma_f32 v100, v100, s23, -v18
    v_mfma_f32_16x16x32_bf16 v[148:151], a[132:135], v[44:47], v[148:151]
    buffer_load_dwordx4 v9, s[8:11], s21 offen offset:1024 nt lds
    v_fma_f32 v101, v101, s23, -v18
    v_mfma_f32_16x16x32_bf16 v[144:147], a[132:135], v[40:43], v[144:147]
    s_waitcnt lgkmcnt(8)
    ds_read_b64_tr_b16 a[132:133], v5 offset:12416
    ds_read_b64_tr_b16 a[134:135], v5 offset:18560
    v_mfma_f32_16x16x32_bf16 v[160:163], a[136:139], v[40:43], v[160:163]
    v_exp_f32 v34, v96
    v_mfma_f32_16x16x32_bf16 v[164:167], a[136:139], v[44:47], v[164:167]
    v_exp_f32 v35, v97
    v_mfma_f32_16x16x32_bf16 v[168:171], a[136:139], v[56:59], v[168:171]
    buffer_load_dwordx4 v10, s[8:11], s21 offen offset:2048 nt lds
    v_fma_f32 v102, v102, s23, -v18
    v_mfma_f32_16x16x32_bf16 v[172:175], a[136:139], v[60:63], v[172:175]
    s_waitcnt lgkmcnt(8)
    ds_read_b64_tr_b16 a[136:137], v2 offset:12544
    ds_read_b64_tr_b16 a[138:139], v2 offset:18688
    v_mfma_f32_16x16x32_bf16 v[188:191], a[140:143], v[60:63], v[188:191]
    s_add_u32 s21, s21, 12288
    v_exp_f32 v36, v98
    v_mfma_f32_16x16x32_bf16 v[184:187], a[140:143], v[56:59], v[184:187]
    v_add_f32 v26, v34, v35
    v_cvt_pk_bf16_f32 v48, v34, v35
    v_mfma_f32_16x16x32_bf16 v[180:183], a[140:143], v[44:47], v[180:183]
    s_xor_b32 s22, s22, 0xc000
    v_exp_f32 v37, v99
    v_mfma_f32_16x16x32_bf16 v[176:179], a[140:143], v[40:43], v[176:179]
    s_waitcnt lgkmcnt(8)
    ds_read_b64_tr_b16 a[140:141], v3 offset:12544
    ds_read_b64_tr_b16 a[142:143], v3 offset:18688
    v_mfma_f32_16x16x32_bf16 v[192:195], a[144:147], v[40:43], v[192:195]
    v_fma_f32 v103, v103, s23, -v18
    v_add_f32 v26, v26, v36
    v_mfma_f32_16x16x32_bf16 v[196:199], a[144:147], v[44:47], v[196:199]
    v_exp_f32 v34, v100
    v_mfma_f32_16x16x32_bf16 v[200:203], a[144:147], v[56:59], v[200:203]
    v_fma_f32 v104, v104, s23, -v19
    v_add_f32 v26, v26, v37
    v_mfma_f32_16x16x32_bf16 v[204:207], a[144:147], v[60:63], v[204:207]
    s_waitcnt lgkmcnt(8)
    ds_read_b64_tr_b16 a[144:145], v4 offset:12544
    ds_read_b64_tr_b16 a[146:147], v4 offset:18688
    v_mfma_f32_16x16x32_bf16 v[220:223], a[148:151], v[60:63], v[220:223]
    s_mov_b32 m0, s38
    v_cvt_pk_bf16_f32 v49, v36, v37
    v_fma_f32 v105, v105, s23, -v19
    v_mfma_f32_16x16x32_bf16 v[216:219], a[148:151], v[56:59], v[216:219]
    v_exp_f32 v35, v101
    v_mfma_f32_16x16x32_bf16 v[212:215], a[148:151], v[44:47], v[212:215]
    buffer_load_dwordx4 v13, s[12:15], s39 offen offset:0 nt lds
    v_add_f32 v26, v26, v34
    v_mfma_f32_16x16x32_bf16 v[208:211], a[148:151], v[40:43], v[208:211]
    s_waitcnt lgkmcnt(8)
    ds_read_b64_tr_b16 a[148:149], v5 offset:12544
    ds_read_b64_tr_b16 a[150:151], v5 offset:18688
    v_mfma_f32_16x16x32_bf16 v[224:227], a[128:131], v[40:43], v[224:227]
    v_exp_f32 v36, v102
    v_mfma_f32_16x16x32_bf16 v[228:231], a[128:131], v[44:47], v[228:231]
    v_fma_f32 v106, v106, s23, -v19
    v_add_f32 v26, v26, v35
    v_mfma_f32_16x16x32_bf16 v[232:235], a[128:131], v[56:59], v[232:235]
    v_cvt_pk_bf16_f32 v50, v34, v35
    v_fma_f32 v107, v107, s23, -v19
    v_mfma_f32_16x16x32_bf16 v[236:239], a[128:131], v[60:63], v[236:239]
    s_waitcnt lgkmcnt(8)
    ds_read_b128 a[128:131], v0 offset:0
    v_add_f32 v26, v26, v36
    v_mfma_f32_16x16x32_bf16 v[252:255], a[132:135], v[60:63], v[252:255]
    v_exp_f32 v37, v103
    v_mfma_f32_16x16x32_bf16 v[248:251], a[132:135], v[56:59], v[248:251]
    v_add_f32 v26, v26, v37
    v_cvt_pk_bf16_f32 v51, v36, v37
    v_mfma_f32_16x16x32_bf16 v[244:247], a[132:135], v[44:47], v[244:247]
    s_bitcmp1_b32 30, s25
    v_exp_f32 v34, v104
    v_mfma_f32_16x16x32_bf16 v[240:243], a[132:135], v[40:43], v[240:243]
    s_waitcnt lgkmcnt(7)
    ds_read_b128 a[132:135], v1 offset:0
    v_fma_f32 v108, v108, s23, -v19
    v_mfma_f32_16x16x32_bf16 a[152:155], a[136:139], v[40:43], a[152:155]
    s_cbranch_scc1 Ldisp3
Lsr4:
    v_exp_f32 v35, v105
    v_mfma_f32_16x16x32_bf16 a[156:159], a[136:139], v[44:47], a[156:159]
    v_fma_f32 v109, v109, s23, -v19
    v_fma_f32 v110, v110, s23, -v19
    v_mfma_f32_16x16x32_bf16 a[160:163], a[136:139], v[56:59], a[160:163]
    v_exp_f32 v36, v106
    v_mfma_f32_16x16x32_bf16 a[164:167], a[136:139], v[60:63], a[164:167]
    s_waitcnt lgkmcnt(6)
    ds_read_b128 a[136:139], v0 offset:128
    v_add_f32 v27, v34, v35
    v_mfma_f32_16x16x32_bf16 a[180:183], a[140:143], v[60:63], a[180:183]
    v_cvt_pk_bf16_f32 v52, v34, v35
    v_fma_f32 v111, v111, s23, -v19
    v_mfma_f32_16x16x32_bf16 a[176:179], a[140:143], v[56:59], a[176:179]
    v_exp_f32 v37, v107
    v_mfma_f32_16x16x32_bf16 a[172:175], a[140:143], v[44:47], a[172:175]
    v_add_f32 v27, v27, v36
    v_fma_f32 v112, v112, s23, -v20
    v_mfma_f32_16x16x32_bf16 a[168:171], a[140:143], v[40:43], a[168:171]
    s_waitcnt lgkmcnt(5)
    ds_read_b128 a[140:143], v1 offset:128
    v_add_f32 v27, v27, v37
    v_mfma_f32_16x16x32_bf16 a[184:187], a[144:147], v[40:43], a[184:187]
    v_exp_f32 v34, v108
    v_mfma_f32_16x16x32_bf16 a[188:191], a[144:147], v[44:47], a[188:191]
    v_cvt_pk_bf16_f32 v53, v36, v37
    v_fma_f32 v113, v113, s23, -v20
    v_mfma_f32_16x16x32_bf16 a[192:195], a[144:147], v[56:59], a[192:195]
    v_exp_f32 v35, v109
    v_mfma_f32_16x16x32_bf16 a[196:199], a[144:147], v[60:63], a[196:199]
    s_waitcnt lgkmcnt(4)
    ds_read_b128 a[144:147], v0 offset:256
    v_add_f32 v27, v27, v34
    v_mfma_f32_16x16x32_bf16 a[212:215], a[148:151], v[60:63], a[212:215]
    v_exp_f32 v36, v110
    v_mfma_f32_16x16x32_bf16 a[208:211], a[148:151], v[56:59], a[208:211]
    v_fma_f32 v114, v114, s23, -v20
    v_add_f32 v27, v27, v35
    v_mfma_f32_16x16x32_bf16 a[204:207], a[148:151], v[44:47], a[204:207]
    v_cvt_pk_bf16_f32 v54, v34, v35
    v_fma_f32 v115, v115, s23, -v20
    v_mfma_f32_16x16x32_bf16 a[200:203], a[148:151], v[40:43], a[200:203]
    s_waitcnt lgkmcnt(4)
    ds_read_b128 a[148:151], v1 offset:256
    v_add_f32 v27, v27, v36
    v_mfma_f32_16x16x32_bf16 v[64:67], a[128:131], a[0:3], 0
    s_waitcnt lgkmcnt(4)
    v_exp_f32 v37, v111
    v_mfma_f32_16x16x32_bf16 v[64:67], a[132:135], a[4:7], v[64:67]
    v_add_f32 v27, v27, v37
    v_cvt_pk_bf16_f32 v55, v36, v37
    v_mfma_f32_16x16x32_bf16 v[72:75], a[128:131], a[8:11], 0
    v_exp_f32 v34, v112
    v_mfma_f32_16x16x32_bf16 v[72:75], a[132:135], a[12:15], v[72:75]
    v_fma_f32 v116, v116, s23, -v20
    v_fma_f32 v117, v117, s23, -v20
    v_mfma_f32_16x16x32_bf16 v[80:83], a[128:131], a[16:19], 0
    v_exp_f32 v35, v113
    v_mfma_f32_16x16x32_bf16 v[80:83], a[132:135], a[20:23], v[80:83]
    v_exp_f32 v36, v114
    v_mfma_f32_16x16x32_bf16 v[88:91], a[128:131], a[24:27], 0
    ds_read_b128 a[128:131], v0 offset:6144
    v_fma_f32 v118, v118, s23, -v20
    v_mfma_f32_16x16x32_bf16 v[88:91], a[132:135], a[28:31], v[88:91]
    s_waitcnt lgkmcnt(4)
    ds_read_b128 a[132:135], v1 offset:6144
    v_add_f32 v28, v34, v35
    v_mfma_f32_16x16x32_bf16 v[64:67], a[136:139], a[32:35], v[64:67]
    s_waitcnt lgkmcnt(4)
    v_cvt_pk_bf16_f32 v56, v34, v35
    v_fma_f32 v119, v119, s23, -v20
    v_mfma_f32_16x16x32_bf16 v[64:67], a[140:143], a[36:39], v[64:67]
    v_exp_f32 v37, v115
    v_mfma_f32_16x16x32_bf16 v[72:75], a[136:139], a[40:43], v[72:75]
    v_add_f32 v28, v28, v36
    v_fma_f32 v120, v120, s23, -v21
    v_mfma_f32_16x16x32_bf16 v[72:75], a[140:143], a[44:47], v[72:75]
    v_exp_f32 v34, v116
    v_mfma_f32_16x16x32_bf16 v[80:83], a[136:139], a[48:51], v[80:83]
    v_add_f32 v28, v28, v37
    v_cvt_pk_bf16_f32 v57, v36, v37
    v_mfma_f32_16x16x32_bf16 v[80:83], a[140:143], a[52:55], v[80:83]
    v_exp_f32 v35, v117
    v_mfma_f32_16x16x32_bf16 v[88:91], a[136:139], a[56:59], v[88:91]
    ds_read_b128 a[136:139], v0 offset:6272
    v_fma_f32 v121, v121, s23, -v21
    v_mfma_f32_16x16x32_bf16 v[88:91], a[140:143], a[60:63], v[88:91]
    s_waitcnt lgkmcnt(4)
    ds_read_b128 a[140:143], v1 offset:6272
    v_add_f32 v28, v28, v34
    v_mfma_f32_16x16x32_bf16 v[64:67], a[144:147], a[64:67], v[64:67]
    s_waitcnt lgkmcnt(4)
    v_exp_f32 v36, v118
    v_mfma_f32_16x16x32_bf16 v[64:67], a[148:151], a[68:71], v[64:67]
    v_fma_f32 v122, v122, s23, -v21
    v_add_f32 v28, v28, v35
    v_mfma_f32_16x16x32_bf16 v[72:75], a[144:147], a[72:75], v[72:75]
    v_cvt_pk_bf16_f32 v58, v34, v35
    v_fma_f32 v123, v123, s23, -v21
    v_mfma_f32_16x16x32_bf16 v[72:75], a[148:151], a[76:79], v[72:75]
    v_exp_f32 v37, v119
    v_mfma_f32_16x16x32_bf16 v[80:83], a[144:147], a[80:83], v[80:83]
    v_add_f32 v28, v28, v36
    v_add_f32 v28, v28, v37
    v_mfma_f32_16x16x32_bf16 v[80:83], a[148:151], a[84:87], v[80:83]
    v_cvt_pk_bf16_f32 v59, v36, v37
    v_fma_f32 v124, v124, s23, -v21
    v_mfma_f32_16x16x32_bf16 v[88:91], a[144:147], a[88:91], v[88:91]
    ds_read_b128 a[144:147], v0 offset:6400
    v_fma_f32 v125, v125, s23, -v21
    v_mfma_f32_16x16x32_bf16 v[88:91], a[148:151], a[92:95], v[88:91]
    s_waitcnt lgkmcnt(4)
    ds_read_b128 a[148:151], v1 offset:6400
    v_fma_f32 v126, v126, s23, -v21
    v_mfma_f32_16x16x32_bf16 v[68:71], a[128:131], a[0:3], 0
    s_waitcnt lgkmcnt(4)
    v_exp_f32 v34, v120
    v_mfma_f32_16x16x32_bf16 v[68:71], a[132:135], a[4:7], v[68:71]
    v_exp_f32 v35, v121
    v_mfma_f32_16x16x32_bf16 v[76:79], a[128:131], a[8:11], 0
    v_exp_f32 v36, v122
    v_mfma_f32_16x16x32_bf16 v[76:79], a[132:135], a[12:15], v[76:79]
    v_add_f32 v29, v34, v35
    v_cvt_pk_bf16_f32 v60, v34, v35
    v_mfma_f32_16x16x32_bf16 v[84:87], a[128:131], a[16:19], 0
    v_exp_f32 v37, v123
    v_mfma_f32_16x16x32_bf16 v[84:87], a[132:135], a[20:23], v[84:87]
    s_waitcnt vmcnt(16) lgkmcnt(0)
    v_fma_f32 v127, v127, s23, -v21
    v_add_f32 v29, v29, v36
    v_mfma_f32_16x16x32_bf16 v[92:95], a[128:131], a[24:27], 0
    s_barrier
    ds_read_b64_tr_b16 a[128:129], v2 offset:36864
    ds_read_b64_tr_b16 a[130:131], v2 offset:43008
    v_mfma_f32_16x16x32_bf16 v[92:95], a[132:135], a[28:31], v[92:95]
    s_add_u32 m0, s22, 0
    ds_read_b64_tr_b16 a[132:133], v3 offset:36864
    ds_read_b64_tr_b16 a[134:135], v3 offset:43008
    v_mfma_f32_16x16x32_bf16 v[68:71], a[136:139], a[32:35], v[68:71]
    buffer_load_dwordx4 v8, s[4:7], s20 offen offset:0 nt lds
    v_add_f32 v29, v29, v37
    v_mfma_f32_16x16x32_bf16 v[68:71], a[140:143], a[36:39], v[68:71]
    v_exp_f32 v34, v124
    v_mfma_f32_16x16x32_bf16 v[76:79], a[136:139], a[40:43], v[76:79]
    v_cvt_pk_bf16_f32 v61, v36, v37
    v_add_f32 v29, v29, v34
    v_mfma_f32_16x16x32_bf16 v[76:79], a[140:143], a[44:47], v[76:79]
    v_exp_f32 v35, v125
    v_mfma_f32_16x16x32_bf16 v[84:87], a[136:139], a[48:51], v[84:87]
    buffer_load_dwordx4 v9, s[4:7], s20 offen offset:1024 nt lds
    v_add_f32 v29, v29, v35
    v_mfma_f32_16x16x32_bf16 v[84:87], a[140:143], a[52:55], v[84:87]
    v_exp_f32 v36, v126
    v_mfma_f32_16x16x32_bf16 v[92:95], a[136:139], a[56:59], v[92:95]
    ds_read_b64_tr_b16 a[136:137], v4 offset:36864
    ds_read_b64_tr_b16 a[138:139], v4 offset:43008
    v_mfma_f32_16x16x32_bf16 v[92:95], a[140:143], a[60:63], v[92:95]
    ds_read_b64_tr_b16 a[140:141], v5 offset:36864
    ds_read_b64_tr_b16 a[142:143], v5 offset:43008
    v_mfma_f32_16x16x32_bf16 v[68:71], a[144:147], a[64:67], v[68:71]
    buffer_load_dwordx4 v10, s[4:7], s20 offen offset:2048 nt lds
    v_cvt_pk_bf16_f32 v62, v34, v35
    v_mfma_f32_16x16x32_bf16 v[68:71], a[148:151], a[68:71], v[68:71]
    s_add_u32 s20, s20, 12288
    v_exp_f32 v37, v127
    v_mfma_f32_16x16x32_bf16 v[76:79], a[144:147], a[72:75], v[76:79]
    v_add_f32 v29, v29, v36
    v_add_f32 v29, v29, v37
    v_mfma_f32_16x16x32_bf16 v[76:79], a[148:151], a[76:79], v[76:79]
    v_cvt_pk_bf16_f32 v63, v36, v37
    v_max3_f32 v39, v26, v27, v28
    v_mfma_f32_16x16x32_bf16 v[84:87], a[144:147], a[80:83], v[84:87]
    v_max_f32 v39, v39, v29
    v_cmp_nge_f32 vcc, 0x44800000, v39
    s_cbranch_vccnz Lrs1
Lrr2:
    v_mfma_f32_16x16x32_bf16 v[84:87], a[148:151], a[84:87], v[84:87]
    s_waitcnt lgkmcnt(6)
    v_add_f32 v22, v22, v26
    v_add_f32 v23, v23, v27
    v_mfma_f32_16x16x32_bf16 v[92:95], a[144:147], a[88:91], v[92:95]
    v_add_f32 v24, v24, v28
    v_add_f32 v25, v25, v29
    v_mfma_f32_16x16x32_bf16 v[92:95], a[148:151], a[92:95], v[92:95]
    v_mfma_f32_16x16x32_bf16 v[128:131], a[128:131], v[48:51], v[128:131]
    ds_read_b64_tr_b16 a[144:145], v2 offset:36992
    ds_read_b64_tr_b16 a[146:147], v2 offset:43136
    v_mfma_f32_16x16x32_bf16 v[132:135], a[128:131], v[52:55], v[132:135]
    s_add_u32 m0, s22, 12288
    ds_read_b64_tr_b16 a[148:149], v3 offset:36992
    ds_read_b64_tr_b16 a[150:151], v3 offset:43136
    v_mfma_f32_16x16x32_bf16 v[136:139], a[128:131], v[56:59], v[136:139]
    buffer_load_dwordx4 v8, s[8:11], s21 offen offset:0 nt lds
    v_fma_f32 v64, v64, s23, -v18
    v_mfma_f32_16x16x32_bf16 v[140:143], a[128:131], v[60:63], v[140:143]
    s_waitcnt lgkmcnt(8)
    ds_read_b64_tr_b16 a[128:129], v4 offset:36992
    ds_read_b64_tr_b16 a[130:131], v4 offset:43136
    v_mfma_f32_16x16x32_bf16 v[156:159], a[132:135], v[60:63], v[156:159]
    v_fma_f32 v65, v65, s23, -v18
    v_fma_f32 v66, v66, s23, -v18
    v_mfma_f32_16x16x32_bf16 v[152:155], a[132:135], v[56:59], v[152:155]
    v_fma_f32 v67, v67, s23, -v18
    v_fma_f32 v68, v68, s23, -v18
    v_mfma_f32_16x16x32_bf16 v[148:151], a[132:135], v[52:55], v[148:151]
    buffer_load_dwordx4 v9, s[8:11], s21 offen offset:1024 nt lds
    v_fma_f32 v69, v69, s23, -v18
    v_mfma_f32_16x16x32_bf16 v[144:147], a[132:135], v[48:51], v[144:147]
    s_waitcnt lgkmcnt(8)
    ds_read_b64_tr_b16 a[132:133], v5 offset:36992
    ds_read_b64_tr_b16 a[134:135], v5 offset:43136
    v_mfma_f32_16x16x32_bf16 v[160:163], a[136:139], v[48:51], v[160:163]
    v_exp_f32 v34, v64
    v_mfma_f32_16x16x32_bf16 v[164:167], a[136:139], v[52:55], v[164:167]
    v_exp_f32 v35, v65
    v_mfma_f32_16x16x32_bf16 v[168:171], a[136:139], v[56:59], v[168:171]
    buffer_load_dwordx4 v10, s[8:11], s21 offen offset:2048 nt lds
    v_fma_f32 v70, v70, s23, -v18
    v_mfma_f32_16x16x32_bf16 v[172:175], a[136:139], v[60:63], v[172:175]
    s_waitcnt lgkmcnt(8)
    ds_read_b64_tr_b16 a[136:137], v2 offset:37120
    ds_read_b64_tr_b16 a[138:139], v2 offset:43264
    v_mfma_f32_16x16x32_bf16 v[188:191], a[140:143], v[60:63], v[188:191]
    s_add_u32 s21, s21, 12288
    v_exp_f32 v36, v66
    v_add_f32 v26, v34, v35
    v_mfma_f32_16x16x32_bf16 v[184:187], a[140:143], v[56:59], v[184:187]
    v_cvt_pk_bf16_f32 v40, v34, v35
    v_fma_f32 v71, v71, s23, -v18
    v_mfma_f32_16x16x32_bf16 v[180:183], a[140:143], v[52:55], v[180:183]
    v_exp_f32 v37, v67
    v_mfma_f32_16x16x32_bf16 v[176:179], a[140:143], v[48:51], v[176:179]
    s_waitcnt lgkmcnt(8)
    ds_read_b64_tr_b16 a[140:141], v3 offset:37120
    ds_read_b64_tr_b16 a[142:143], v3 offset:43264
    v_mfma_f32_16x16x32_bf16 v[192:195], a[144:147], v[48:51], v[192:195]
    v_add_f32 v26, v26, v36
    v_fma_f32 v72, v72, s23, -v19
    v_mfma_f32_16x16x32_bf16 v[196:199], a[144:147], v[52:55], v[196:199]
    v_exp_f32 v34, v68
    v_mfma_f32_16x16x32_bf16 v[200:203], a[144:147], v[56:59], v[200:203]
    v_add_f32 v26, v26, v37
    v_cvt_pk_bf16_f32 v41, v36, v37
    v_mfma_f32_16x16x32_bf16 v[204:207], a[144:147], v[60:63], v[204:207]
    s_waitcnt lgkmcnt(8)
    ds_read_b64_tr_b16 a[144:145], v4 offset:37120
    ds_read_b64_tr_b16 a[146:147], v4 offset:43264
    v_mfma_f32_16x16x32_bf16 v[220:223], a[148:151], v[60:63], v[220:223]
    s_add_u32 m0, s38, 8064
    v_exp_f32 v35, v69
    v_mfma_f32_16x16x32_bf16 v[216:219], a[148:151], v[56:59], v[216:219]
    v_fma_f32 v73, v73, s23, -v19
    v_add_f32 v26, v26, v34
    v_mfma_f32_16x16x32_bf16 v[212:215], a[148:151], v[52:55], v[212:215]
    buffer_load_dwordx4 v13, s[12:15], s39 offen offset:128 nt lds
    v_fma_f32 v74, v74, s23, -v19
    v_mfma_f32_16x16x32_bf16 v[208:211], a[148:151], v[48:51], v[208:211]
    s_waitcnt lgkmcnt(8)
    ds_read_b64_tr_b16 a[148:149], v5 offset:37120
    ds_read_b64_tr_b16 a[150:151], v5 offset:43264
    v_mfma_f32_16x16x32_bf16 v[224:227], a[128:131], v[48:51], v[224:227]
    s_add_u32 s38, s38, 1024
    v_exp_f32 v36, v70
    v_mfma_f32_16x16x32_bf16 v[228:231], a[128:131], v[52:55], v[228:231]
    s_add_u32 s39, s39, 3072
    v_add_f32 v26, v26, v35
    v_cvt_pk_bf16_f32 v42, v34, v35
    v_fma_f32 v75, v75, s23, -v19
    v_mfma_f32_16x16x32_bf16 v[232:235], a[128:131], v[56:59], v[232:235]
    v_exp_f32 v37, v71
    v_mfma_f32_16x16x32_bf16 v[236:239], a[128:131], v[60:63], v[236:239]
    s_waitcnt lgkmcnt(8)
    ds_read_b128 a[128:131], v0 offset:24576
    v_add_f32 v26, v26, v36
    v_mfma_f32_16x16x32_bf16 v[252:255], a[132:135], v[60:63], v[252:255]
    v_add_f32 v26, v26, v37
    v_xor_b32 v2, 0xc000, v2
    v_mfma_f32_16x16x32_bf16 v[248:251], a[132:135], v[56:59], v[248:251]
    v_cvt_pk_bf16_f32 v43, v36, v37
    v_xor_b32 v3, 0xc000, v3
    v_mfma_f32_16x16x32_bf16 v[244:247], a[132:135], v[52:55], v[244:247]
    v_exp_f32 v34, v72
    v_mfma_f32_16x16x32_bf16 v[240:243], a[132:135], v[48:51], v[240:243]
    s_waitcnt lgkmcnt(7)
    ds_read_b128 a[132:135], v1 offset:24576
    v_fma_f32 v76, v76, s23, -v19
    v_mfma_f32_16x16x32_bf16 a[152:155], a[136:139], v[48:51], a[152:155]
    v_xor_b32 v4, 0xc000, v4
    v_xor_b32 v5, 0xc000, v5
    v_mfma_f32_16x16x32_bf16 a[156:159], a[136:139], v[52:55], a[156:159]
    v_exp_f32 v35, v73
    v_mfma_f32_16x16x32_bf16 a[160:163], a[136:139], v[56:59], a[160:163]
    v_fma_f32 v77, v77, s23, -v19
    v_fma_f32 v78, v78, s23, -v19
    v_mfma_f32_16x16x32_bf16 a[164:167], a[136:139], v[60:63], a[164:167]
    s_waitcnt lgkmcnt(6)
    ds_read_b128 a[136:139], v0 offset:24704
    v_add_f32 v27, v34, v35
    v_mfma_f32_16x16x32_bf16 a[180:183], a[140:143], v[60:63], a[180:183]
    v_exp_f32 v36, v74
    v_mfma_f32_16x16x32_bf16 a[176:179], a[140:143], v[56:59], a[176:179]
    v_cvt_pk_bf16_f32 v44, v34, v35
    v_exp_f32 v37, v75
    v_mfma_f32_16x16x32_bf16 a[172:175], a[140:143], v[52:55], a[172:175]
    v_fma_f32 v79, v79, s23, -v19
    v_add_f32 v27, v27, v36
    v_mfma_f32_16x16x32_bf16 a[168:171], a[140:143], v[48:51], a[168:171]
    s_waitcnt lgkmcnt(5)
    ds_read_b128 a[140:143], v1 offset:24704
    v_fma_f32 v80, v80, s23, -v20
    v_mfma_f32_16x16x32_bf16 a[184:187], a[144:147], v[48:51], a[184:187]
    v_exp_f32 v34, v76
    v_mfma_f32_16x16x32_bf16 a[188:191], a[144:147], v[52:55], a[188:191]
    v_add_f32 v27, v27, v37
    v_cvt_pk_bf16_f32 v45, v36, v37
    v_mfma_f32_16x16x32_bf16 a[192:195], a[144:147], v[56:59], a[192:195]
    v_exp_f32 v35, v77
    v_mfma_f32_16x16x32_bf16 a[196:199], a[144:147], v[60:63], a[196:199]
    s_waitcnt lgkmcnt(4)
    ds_read_b128 a[144:147], v0 offset:24832
    v_fma_f32 v81, v81, s23, -v20
    v_mfma_f32_16x16x32_bf16 a[212:215], a[148:151], v[60:63], a[212:215]
    v_add_f32 v27, v27, v34
    v_fma_f32 v82, v82, s23, -v20
    v_mfma_f32_16x16x32_bf16 a[208:211], a[148:151], v[56:59], a[208:211]
    v_exp_f32 v36, v78
    v_mfma_f32_16x16x32_bf16 a[204:207], a[148:151], v[52:55], a[204:207]
    v_add_f32 v27, v27, v35
    v_cvt_pk_bf16_f32 v46, v34, v35
    v_mfma_f32_16x16x32_bf16 a[200:203], a[148:151], v[48:51], a[200:203]
    s_waitcnt lgkmcnt(4)
    ds_read_b128 a[148:151], v1 offset:24832
    v_fma_f32 v83, v83, s23, -v20
    v_mfma_f32_16x16x32_bf16 v[96:99], a[128:131], a[0:3], 0
    s_waitcnt lgkmcnt(4)
    v_exp_f32 v37, v79
    v_mfma_f32_16x16x32_bf16 v[96:99], a[132:135], a[4:7], v[96:99]
    v_add_f32 v27, v27, v36
    v_add_f32 v27, v27, v37
    v_mfma_f32_16x16x32_bf16 v[104:107], a[128:131], a[8:11], 0
    global_load_dwordx4 a[228:231], v[6:7], off
    v_cvt_pk_bf16_f32 v47, v36, v37
    v_fma_f32 v84, v84, s23, -v20
    v_mfma_f32_16x16x32_bf16 v[104:107], a[132:135], a[12:15], v[104:107]
    v_exp_f32 v34, v80
    v_mfma_f32_16x16x32_bf16 v[112:115], a[128:131], a[16:19], 0
    v_exp_f32 v35, v81
    v_mfma_f32_16x16x32_bf16 v[112:115], a[132:135], a[20:23], v[112:115]
    v_fma_f32 v85, v85, s23, -v20
    v_fma_f32 v86, v86, s23, -v20
    v_mfma_f32_16x16x32_bf16 v[120:123], a[128:131], a[24:27], 0
    ds_read_b128 a[128:131], v0 offset:30720
    v_add_f32 v28, v34, v35
    v_mfma_f32_16x16x32_bf16 v[120:123], a[132:135], a[28:31], v[120:123]
    s_waitcnt lgkmcnt(4)
    ds_read_b128 a[132:135], v1 offset:30720
    v_cvt_pk_bf16_f32 v56, v34, v35
    v_mfma_f32_16x16x32_bf16 v[96:99], a[136:139], a[32:35], v[96:99]
    s_waitcnt lgkmcnt(4)
    v_exp_f32 v36, v82
    v_mfma_f32_16x16x32_bf16 v[96:99], a[140:143], a[36:39], v[96:99]
    v_exp_f32 v37, v83
    v_mfma_f32_16x16x32_bf16 v[104:107], a[136:139], a[40:43], v[104:107]
    v_fma_f32 v87, v87, s23, -v20
    v_add_f32 v28, v28, v36
    v_mfma_f32_16x16x32_bf16 v[104:107], a[140:143], a[44:47], v[104:107]
    v_exp_f32 v34, v84
    v_mfma_f32_16x16x32_bf16 v[112:115], a[136:139], a[48:51], v[112:115]
    v_fma_f32 v88, v88, s23, -v21
    v_add_f32 v28, v28, v37
    v_mfma_f32_16x16x32_bf16 v[112:115], a[140:143], a[52:55], v[112:115]
    v_cvt_pk_bf16_f32 v57, v36, v37
    v_fma_f32 v89, v89, s23, -v21
    v_mfma_f32_16x16x32_bf16 v[120:123], a[136:139], a[56:59], v[120:123]
    ds_read_b128 a[136:139], v0 offset:30848
    v_add_f32 v28, v28, v34
    v_mfma_f32_16x16x32_bf16 v[120:123], a[140:143], a[60:63], v[120:123]
    s_waitcnt lgkmcnt(4)
    ds_read_b128 a[140:143], v1 offset:30848
    v_exp_f32 v35, v85
    v_mfma_f32_16x16x32_bf16 v[96:99], a[144:147], a[64:67], v[96:99]
    s_waitcnt lgkmcnt(4)
    v_exp_f32 v36, v86
    v_mfma_f32_16x16x32_bf16 v[96:99], a[148:151], a[68:71], v[96:99]
    v_fma_f32 v90, v90, s23, -v21
    v_add_f32 v28, v28, v35
    v_mfma_f32_16x16x32_bf16 v[104:107], a[144:147], a[72:75], v[104:107]
    v_cvt_pk_bf16_f32 v58, v34, v35
    v_fma_f32 v91, v91, s23, -v21
    v_mfma_f32_16x16x32_bf16 v[104:107], a[148:151], a[76:79], v[104:107]
    v_exp_f32 v37, v87
    v_mfma_f32_16x16x32_bf16 v[112:115], a[144:147], a[80:83], v[112:115]
    v_add_f32 v28, v28, v36
    v_add_f32 v28, v28, v37
    v_mfma_f32_16x16x32_bf16 v[112:115], a[148:151], a[84:87], v[112:115]
    v_cvt_pk_bf16_f32 v59, v36, v37
    v_fma_f32 v92, v92, s23, -v21
    v_mfma_f32_16x16x32_bf16 v[120:123], a[144:147], a[88:91], v[120:123]
    ds_read_b128 a[144:147], v0 offset:30976
    v_fma_f32 v93, v93, s23, -v21
    v_mfma_f32_16x16x32_bf16 v[120:123], a[148:151], a[92:95], v[120:123]
    s_waitcnt lgkmcnt(4)
    ds_read_b128 a[148:151], v1 offset:30976
    v_xor_b32 v0, 0xc000, v0
    v_mfma_f32_16x16x32_bf16 v[100:103], a[128:131], a[0:3], 0
    s_waitcnt lgkmcnt(4)
    v_exp_f32 v34, v88
    v_mfma_f32_16x16x32_bf16 v[100:103], a[132:135], a[4:7], v[100:103]
    v_exp_f32 v35, v89
    v_mfma_f32_16x16x32_bf16 v[108:111], a[128:131], a[8:11], 0
    s_add_u32 s25, s25, 1
    v_exp_f32 v36, v90
    v_mfma_f32_16x16x32_bf16 v[108:111], a[132:135], a[12:15], v[108:111]
    v_fma_f32 v94, v94, s23, -v21
    v_add_f32 v29, v34, v35
    v_xor_b32 v1, 0xc000, v1
    v_mfma_f32_16x16x32_bf16 v[116:119], a[128:131], a[16:19], 0
    v_cvt_pk_bf16_f32 v60, v34, v35
    v_fma_f32 v95, v95, s23, -v21
    v_mfma_f32_16x16x32_bf16 v[116:119], a[132:135], a[20:23], v[116:119]
    s_waitcnt vmcnt(17) lgkmcnt(0)
    v_exp_f32 v37, v91
    v_mfma_f32_16x16x32_bf16 v[124:127], a[128:131], a[24:27], 0
    s_barrier
    ds_read_b64_tr_b16 a[128:129], v2 offset:12288
    ds_read_b64_tr_b16 a[130:131], v2 offset:18432
    v_mfma_f32_16x16x32_bf16 v[124:127], a[132:135], a[28:31], v[124:127]
    s_add_u32 m0, s22, 24576
    ds_read_b64_tr_b16 a[132:133], v3 offset:12288
    ds_read_b64_tr_b16 a[134:135], v3 offset:18432
    v_mfma_f32_16x16x32_bf16 v[100:103], a[136:139], a[32:35], v[100:103]
    buffer_load_dwordx4 v8, s[4:7], s20 offen offset:0 nt lds
    v_add_f32 v29, v29, v36
    v_mfma_f32_16x16x32_bf16 v[100:103], a[140:143], a[36:39], v[100:103]
    v_exp_f32 v34, v92
    v_mfma_f32_16x16x32_bf16 v[108:111], a[136:139], a[40:43], v[108:111]
    v_add_f32 v29, v29, v37
    v_cvt_pk_bf16_f32 v61, v36, v37
    v_mfma_f32_16x16x32_bf16 v[108:111], a[140:143], a[44:47], v[108:111]
    v_exp_f32 v35, v93
    v_mfma_f32_16x16x32_bf16 v[116:119], a[136:139], a[48:51], v[116:119]
    buffer_load_dwordx4 v9, s[4:7], s20 offen offset:1024 nt lds
    v_add_f32 v29, v29, v34
    v_mfma_f32_16x16x32_bf16 v[116:119], a[140:143], a[52:55], v[116:119]
    v_exp_f32 v36, v94
    v_mfma_f32_16x16x32_bf16 v[124:127], a[136:139], a[56:59], v[124:127]
    ds_read_b64_tr_b16 a[136:137], v4 offset:12288
    ds_read_b64_tr_b16 a[138:139], v4 offset:18432
    v_mfma_f32_16x16x32_bf16 v[124:127], a[140:143], a[60:63], v[124:127]
    ds_read_b64_tr_b16 a[140:141], v5 offset:12288
    ds_read_b64_tr_b16 a[142:143], v5 offset:18432
    v_mfma_f32_16x16x32_bf16 v[100:103], a[144:147], a[64:67], v[100:103]
    buffer_load_dwordx4 v10, s[4:7], s20 offen offset:2048 nt lds
    v_add_f32 v29, v29, v35
    v_cvt_pk_bf16_f32 v62, v34, v35
    v_mfma_f32_16x16x32_bf16 v[100:103], a[148:151], a[68:71], v[100:103]
    s_add_u32 s20, s20, 12288
    v_exp_f32 v37, v95
    v_mfma_f32_16x16x32_bf16 v[108:111], a[144:147], a[72:75], v[108:111]
    v_add_f32 v29, v29, v36
    v_add_f32 v29, v29, v37
    v_mfma_f32_16x16x32_bf16 v[108:111], a[148:151], a[76:79], v[108:111]
    v_cvt_pk_bf16_f32 v63, v36, v37
    v_max3_f32 v39, v26, v27, v28
    v_mfma_f32_16x16x32_bf16 v[116:119], a[144:147], a[80:83], v[116:119]
    v_max_f32 v39, v39, v29
    v_cmp_nge_f32 vcc, 0x44800000, v39
    s_cbranch_vccnz Lrs5
Lrr6:
    v_mfma_f32_16x16x32_bf16 v[116:119], a[148:151], a[84:87], v[116:119]
    s_waitcnt lgkmcnt(6)
    v_add_f32 v22, v22, v26
    v_add_f32 v23, v23, v27
    v_mfma_f32_16x16x32_bf16 v[124:127], a[144:147], a[88:91], v[124:127]
    s_cmp_lt_u32 s25, 7
    v_add_f32 v24, v24, v28
    v_add_f32 v25, v25, v29
    v_mfma_f32_16x16x32_bf16 v[124:127], a[148:151], a[92:95], v[124:127]
    s_cbranch_scc1 Lloop1
    v_mfma_f32_16x16x32_bf16 v[128:131], a[128:131], v[40:43], v[128:131]
    ds_read_b64_tr_b16 a[144:145], v2 offset:12416
    ds_read_b64_tr_b16 a[146:147], v2 offset:18560
    v_mfma_f32_16x16x32_bf16 v[132:135], a[128:131], v[44:47], v[132:135]
    s_add_u32 m0, s22, 36864
    ds_read_b64_tr_b16 a[148:149], v3 offset:12416
    ds_read_b64_tr_b16 a[150:151], v3 offset:18560
    v_mfma_f32_16x16x32_bf16 v[136:139], a[128:131], v[56:59], v[136:139]
    buffer_load_dwordx4 v8, s[8:11], s21 offen offset:0 nt lds
    v_fma_f32 v96, v96, s23, -v18
    v_mfma_f32_16x16x32_bf16 v[140:143], a[128:131], v[60:63], v[140:143]
    s_waitcnt lgkmcnt(8)
    ds_read_b64_tr_b16 a[128:129], v4 offset:12416
    ds_read_b64_tr_b16 a[130:131], v4 offset:18560
    v_mfma_f32_16x16x32_bf16 v[156:159], a[132:135], v[60:63], v[156:159]
    s_waitcnt vmcnt(63)
    ds_read_b128 a[0:3], v14 offset:0
    ds_read_b128 a[4:7], v15 offset:0
    v_mfma_f32_16x16x32_bf16 v[152:155], a[132:135], v[56:59], v[152:155]
    ds_read_b128 a[32:35], v14 offset:8192
    ds_read_b128 a[36:39], v15 offset:8192
    v_mfma_f32_16x16x32_bf16 v[148:151], a[132:135], v[44:47], v[148:151]
    buffer_load_dwordx4 v9, s[8:11], s21 offen offset:1024 nt lds
    v_fma_f32 v97, v97, s23, -v18
    v_fma_f32 v98, v98, s23, -v18
    v_mfma_f32_16x16x32_bf16 v[144:147], a[132:135], v[40:43], v[144:147]
    s_waitcnt lgkmcnt(12)
    ds_read_b64_tr_b16 a[132:133], v5 offset:12416
    ds_read_b64_tr_b16 a[134:135], v5 offset:18560
    v_mfma_f32_16x16x32_bf16 v[160:163], a[136:139], v[40:43], v[160:163]
    v_fma_f32 v99, v99, s23, -v18
    v_fma_f32 v100, v100, s23, -v18
    v_mfma_f32_16x16x32_bf16 v[164:167], a[136:139], v[44:47], v[164:167]
    v_exp_f32 v34, v96
    v_mfma_f32_16x16x32_bf16 v[168:171], a[136:139], v[56:59], v[168:171]
    buffer_load_dwordx4 v10, s[8:11], s21 offen offset:2048 nt lds
    v_fma_f32 v101, v101, s23, -v18
    v_mfma_f32_16x16x32_bf16 v[172:175], a[136:139], v[60:63], v[172:175]
    s_waitcnt lgkmcnt(12)
    ds_read_b64_tr_b16 a[136:137], v2 offset:12544
    ds_read_b64_tr_b16 a[138:139], v2 offset:18688
    v_mfma_f32_16x16x32_bf16 v[188:191], a[140:143], v[60:63], v[188:191]
    s_add_u32 s21, s21, 12288
    v_exp_f32 v35, v97
    v_fma_f32 v102, v102, s23, -v18
    v_mfma_f32_16x16x32_bf16 v[184:187], a[140:143], v[56:59], v[184:187]
    v_exp_f32 v36, v98
    v_mfma_f32_16x16x32_bf16 v[180:183], a[140:143], v[44:47], v[180:183]
    s_waitcnt vmcnt(63)
    ds_read_b128 a[8:11], v14 offset:2048
    ds_read_b128 a[12:15], v15 offset:2048
    v_mfma_f32_16x16x32_bf16 v[176:179], a[140:143], v[40:43], v[176:179]
    s_waitcnt lgkmcnt(14)
    ds_read_b64_tr_b16 a[140:141], v3 offset:12544
    ds_read_b64_tr_b16 a[142:143], v3 offset:18688
    v_mfma_f32_16x16x32_bf16 v[192:195], a[144:147], v[40:43], v[192:195]
    s_xor_b32 s22, s22, 0xc000
    ds_read_b128 a[40:43], v14 offset:10240
    ds_read_b128 a[44:47], v15 offset:10240
    v_mfma_f32_16x16x32_bf16 v[196:199], a[144:147], v[44:47], v[196:199]
    v_add_f32 v26, v34, v35
    v_cvt_pk_bf16_f32 v48, v34, v35
    v_mfma_f32_16x16x32_bf16 v[200:203], a[144:147], v[56:59], v[200:203]
    v_exp_f32 v37, v99
    v_fma_f32 v103, v103, s23, -v18
    v_mfma_f32_16x16x32_bf16 v[204:207], a[144:147], v[60:63], v[204:207]
    s_waitcnt lgkmcnt(15)
    ds_read_b64_tr_b16 a[144:145], v4 offset:12544
    ds_read_b64_tr_b16 a[146:147], v4 offset:18688
    v_mfma_f32_16x16x32_bf16 v[220:223], a[148:151], v[60:63], v[220:223]
    v_add_f32 v26, v26, v36
    v_fma_f32 v104, v104, s23, -v19
    v_mfma_f32_16x16x32_bf16 v[216:219], a[148:151], v[56:59], v[216:219]
    v_exp_f32 v34, v100
    v_mfma_f32_16x16x32_bf16 v[212:215], a[148:151], v[44:47], v[212:215]
    v_add_f32 v26, v26, v37
    v_cvt_pk_bf16_f32 v49, v36, v37
    v_mfma_f32_16x16x32_bf16 v[208:211], a[148:151], v[40:43], v[208:211]
    s_waitcnt lgkmcnt(15)
    ds_read_b64_tr_b16 a[148:149], v5 offset:12544
    ds_read_b64_tr_b16 a[150:151], v5 offset:18688
    v_mfma_f32_16x16x32_bf16 v[224:227], a[128:131], v[40:43], v[224:227]
    s_waitcnt vmcnt(37)
    ds_read_b128 a[16:19], v14 offset:4096
    ds_read_b128 a[20:23], v15 offset:4096
    v_fma_f32 v105, v105, s23, -v19
    v_mfma_f32_16x16x32_bf16 v[228:231], a[128:131], v[44:47], v[228:231]
    ds_read_b128 a[48:51], v14 offset:12288
    ds_read_b128 a[52:55], v15 offset:12288
    v_mfma_f32_16x16x32_bf16 v[232:235], a[128:131], v[56:59], v[232:235]
    v_exp_f32 v35, v101
    v_mfma_f32_16x16x32_bf16 v[236:239], a[128:131], v[60:63], v[236:239]
    s_waitcnt lgkmcnt(15)
    ds_read_b128 a[128:131], v0 offset:0
    v_add_f32 v26, v26, v34
    v_mfma_f32_16x16x32_bf16 v[252:255], a[132:135], v[60:63], v[252:255]
    v_exp_f32 v36, v102
    v_mfma_f32_16x16x32_bf16 v[248:251], a[132:135], v[56:59], v[248:251]
    v_fma_f32 v106, v106, s23, -v19
    v_add_f32 v26, v26, v35
    v_mfma_f32_16x16x32_bf16 v[244:247], a[132:135], v[44:47], v[244:247]
    v_cvt_pk_bf16_f32 v50, v34, v35
    v_exp_f32 v37, v103
    v_mfma_f32_16x16x32_bf16 v[240:243], a[132:135], v[40:43], v[240:243]
    s_waitcnt lgkmcnt(15)
    ds_read_b128 a[132:135], v1 offset:0
    v_fma_f32 v107, v107, s23, -v19
    v_mfma_f32_16x16x32_bf16 a[152:155], a[136:139], v[40:43], a[152:155]
    v_add_f32 v26, v26, v36
    v_add_f32 v26, v26, v37
    v_mfma_f32_16x16x32_bf16 a[156:159], a[136:139], v[44:47], a[156:159]
    v_cvt_pk_bf16_f32 v51, v36, v37
    v_fma_f32 v108, v108, s23, -v19
    v_mfma_f32_16x16x32_bf16 a[160:163], a[136:139], v[56:59], a[160:163]
    s_waitcnt vmcnt(7)
    ds_read_b128 a[24:27], v14 offset:6144
    ds_read_b128 a[28:31], v15 offset:6144
    v_mfma_f32_16x16x32_bf16 a[164:167], a[136:139], v[60:63], a[164:167]
    s_waitcnt lgkmcnt(14)
    ds_read_b128 a[136:139], v0 offset:128
    ds_read_b128 a[56:59], v14 offset:14336
    v_mfma_f32_16x16x32_bf16 a[180:183], a[140:143], v[60:63], a[180:183]
    ds_read_b128 a[60:63], v15 offset:14336
    v_exp_f32 v34, v104
    v_mfma_f32_16x16x32_bf16 a[176:179], a[140:143], v[56:59], a[176:179]
    v_exp_f32 v35, v105
    v_mfma_f32_16x16x32_bf16 a[172:175], a[140:143], v[44:47], a[172:175]
    v_fma_f32 v109, v109, s23, -v19
    v_fma_f32 v110, v110, s23, -v19
    v_mfma_f32_16x16x32_bf16 a[168:171], a[140:143], v[40:43], a[168:171]
    s_waitcnt lgkmcnt(13)
    ds_read_b128 a[140:143], v1 offset:128
    v_add_f32 v27, v34, v35
    v_mfma_f32_16x16x32_bf16 a[184:187], a[144:147], v[40:43], a[184:187]
    v_exp_f32 v36, v106
    v_mfma_f32_16x16x32_bf16 a[188:191], a[144:147], v[44:47], a[188:191]
    v_cvt_pk_bf16_f32 v52, v34, v35
    v_fma_f32 v111, v111, s23, -v19
    v_mfma_f32_16x16x32_bf16 a[192:195], a[144:147], v[56:59], a[192:195]
    v_exp_f32 v37, v107
    v_add_f32 v27, v27, v36
    v_mfma_f32_16x16x32_bf16 a[196:199], a[144:147], v[60:63], a[196:199]
    s_waitcnt lgkmcnt(12)
    ds_read_b128 a[144:147], v0 offset:256
    v_fma_f32 v112, v112, s23, -v20
    v_mfma_f32_16x16x32_bf16 a[212:215], a[148:151], v[60:63], a[212:215]
    v_exp_f32 v34, v108
    v_mfma_f32_16x16x32_bf16 a[208:211], a[148:151], v[56:59], a[208:211]
    v_add_f32 v27, v27, v37
    v_cvt_pk_bf16_f32 v53, v36, v37
    v_mfma_f32_16x16x32_bf16 a[204:207], a[148:151], v[44:47], a[204:207]
    v_exp_f32 v35, v109
    v_mfma_f32_16x16x32_bf16 a[200:203], a[148:151], v[40:43], a[200:203]
    s_waitcnt lgkmcnt(8)
    ds_read_b128 a[148:151], v1 offset:256
    v_fma_f32 v113, v113, s23, -v20
    v_mfma_f32_16x16x32_bf16 v[64:67], a[128:131], a[0:3], 0
    s_waitcnt lgkmcnt(8)
    v_add_f32 v27, v27, v34
    v_fma_f32 v114, v114, s23, -v20
    v_mfma_f32_16x16x32_bf16 v[64:67], a[132:135], a[4:7], v[64:67]
    v_exp_f32 v36, v110
    v_add_f32 v27, v27, v35
    v_mfma_f32_16x16x32_bf16 v[72:75], a[128:131], a[8:11], 0
    v_cvt_pk_bf16_f32 v54, v34, v35
    v_fma_f32 v115, v115, s23, -v20
    v_mfma_f32_16x16x32_bf16 v[72:75], a[132:135], a[12:15], v[72:75]
    v_exp_f32 v37, v111
    v_mfma_f32_16x16x32_bf16 v[80:83], a[128:131], a[16:19], 0
    v_add_f32 v27, v27, v36
    v_add_f32 v27, v27, v37
    v_mfma_f32_16x16x32_bf16 v[80:83], a[132:135], a[20:23], v[80:83]
    s_waitcnt lgkmcnt(7)
    v_cvt_pk_bf16_f32 v55, v36, v37
    v_fma_f32 v116, v116, s23, -v20
    v_mfma_f32_16x16x32_bf16 v[88:91], a[128:131], a[24:27], 0
    s_waitcnt lgkmcnt(6)
    ds_read_b128 a[128:131], v0 offset:6144
    v_fma_f32 v117, v117, s23, -v20
    v_mfma_f32_16x16x32_bf16 v[88:91], a[132:135], a[28:31], v[88:91]
    s_waitcnt lgkmcnt(6)
    ds_read_b128 a[132:135], v1 offset:6144
    v_exp_f32 v34, v112
    v_mfma_f32_16x16x32_bf16 v[64:67], a[136:139], a[32:35], v[64:67]
    s_waitcnt lgkmcnt(4)
    v_exp_f32 v35, v113
    v_mfma_f32_16x16x32_bf16 v[64:67], a[140:143], a[36:39], v[64:67]
    v_exp_f32 v36, v114
    v_mfma_f32_16x16x32_bf16 v[72:75], a[136:139], a[40:43], v[72:75]
    v_fma_f32 v118, v118, s23, -v20
    v_add_f32 v28, v34, v35
    v_mfma_f32_16x16x32_bf16 v[72:75], a[140:143], a[44:47], v[72:75]
    v_cvt_pk_bf16_f32 v56, v34, v35
    v_fma_f32 v119, v119, s23, -v20
    v_mfma_f32_16x16x32_bf16 v[80:83], a[136:139], a[48:51], v[80:83]
    v_exp_f32 v37, v115
    v_mfma_f32_16x16x32_bf16 v[80:83], a[140:143], a[52:55], v[80:83]
    v_add_f32 v28, v28, v36
    v_exp_f32 v34, v116
    v_mfma_f32_16x16x32_bf16 v[88:91], a[136:139], a[56:59], v[88:91]
    ds_read_b128 a[136:139], v0 offset:6272
    v_fma_f32 v120, v120, s23, -v21
    v_mfma_f32_16x16x32_bf16 v[88:91], a[140:143], a[60:63], v[88:91]
    s_waitcnt vmcnt(63) lgkmcnt(4)
    ds_read_b128 a[140:143], v1 offset:6272
    v_add_f32 v28, v28, v37
    v_mfma_f32_16x16x32_bf16 v[64:67], a[144:147], a[96:99], v[64:67]
    s_waitcnt vmcnt(63) lgkmcnt(4)
    v_cvt_pk_bf16_f32 v57, v36, v37
    v_fma_f32 v121, v121, s23, -v21
    v_mfma_f32_16x16x32_bf16 v[64:67], a[148:151], a[100:103], v[64:67]
    s_waitcnt vmcnt(63)
    v_exp_f32 v35, v117
    v_mfma_f32_16x16x32_bf16 v[72:75], a[144:147], a[104:107], v[72:75]
    s_waitcnt vmcnt(63)
    v_add_f32 v28, v28, v34
    v_fma_f32 v122, v122, s23, -v21
    v_mfma_f32_16x16x32_bf16 v[72:75], a[148:151], a[108:111], v[72:75]
    s_waitcnt vmcnt(62)
    v_exp_f32 v36, v118
    v_add_f32 v28, v28, v35
    v_mfma_f32_16x16x32_bf16 v[80:83], a[144:147], a[112:115], v[80:83]
    s_waitcnt vmcnt(61)
    v_cvt_pk_bf16_f32 v58, v34, v35
    v_fma_f32 v123, v123, s23, -v21
    v_mfma_f32_16x16x32_bf16 v[80:83], a[148:151], a[116:119], v[80:83]
    s_waitcnt vmcnt(45)
    v_exp_f32 v37, v119
    v_mfma_f32_16x16x32_bf16 v[88:91], a[144:147], a[120:123], v[88:91]
    s_waitcnt vmcnt(44)
    ds_read_b128 a[144:147], v0 offset:6400
    v_add_f32 v28, v28, v36
    v_mfma_f32_16x16x32_bf16 v[88:91], a[148:151], a[124:127], v[88:91]
    s_waitcnt lgkmcnt(4)
    ds_read_b128 a[148:151], v1 offset:6400
    v_add_f32 v28, v28, v37
    v_mfma_f32_16x16x32_bf16 v[68:71], a[128:131], a[0:3], 0
    s_waitcnt lgkmcnt(4)
    v_cvt_pk_bf16_f32 v59, v36, v37
    v_fma_f32 v124, v124, s23, -v21
    v_mfma_f32_16x16x32_bf16 v[68:71], a[132:135], a[4:7], v[68:71]
    v_exp_f32 v34, v120
    v_fma_f32 v125, v125, s23, -v21
    v_mfma_f32_16x16x32_bf16 v[76:79], a[128:131], a[8:11], 0
    v_exp_f32 v35, v121
    v_mfma_f32_16x16x32_bf16 v[76:79], a[132:135], a[12:15], v[76:79]
    v_exp_f32 v36, v122
    v_mfma_f32_16x16x32_bf16 v[84:87], a[128:131], a[16:19], 0
    v_fma_f32 v126, v126, s23, -v21
    v_add_f32 v29, v34, v35
    v_mfma_f32_16x16x32_bf16 v[84:87], a[132:135], a[20:23], v[84:87]
    s_waitcnt vmcnt(15) lgkmcnt(0)
    v_cvt_pk_bf16_f32 v60, v34, v35
    v_fma_f32 v127, v127, s23, -v21
    v_mfma_f32_16x16x32_bf16 v[92:95], a[128:131], a[24:27], 0
    s_barrier
    ds_read_b64_tr_b16 a[128:129], v2 offset:36864
    ds_read_b64_tr_b16 a[130:131], v2 offset:43008
    v_mfma_f32_16x16x32_bf16 v[92:95], a[132:135], a[28:31], v[92:95]
    s_add_u32 m0, s22, 0
    ds_read_b64_tr_b16 a[132:133], v3 offset:36864
    ds_read_b64_tr_b16 a[134:135], v3 offset:43008
    v_add_f32 v29, v29, v36
    v_mfma_f32_16x16x32_bf16 v[68:71], a[136:139], a[32:35], v[68:71]
    buffer_load_dwordx4 v8, s[4:7], s20 offen offset:0 nt lds
    v_max3_f32 v39, v26, v27, v28
    v_mfma_f32_16x16x32_bf16 v[68:71], a[140:143], a[36:39], v[68:71]
    v_exp_f32 v37, v123
    v_mfma_f32_16x16x32_bf16 v[76:79], a[136:139], a[40:43], v[76:79]
    v_exp_f32 v34, v124
    v_mfma_f32_16x16x32_bf16 v[76:79], a[140:143], a[44:47], v[76:79]
    v_add_f32 v29, v29, v37
    v_cvt_pk_bf16_f32 v61, v36, v37
    v_mfma_f32_16x16x32_bf16 v[84:87], a[136:139], a[48:51], v[84:87]
    buffer_load_dwordx4 v9, s[4:7], s20 offen offset:1024 nt lds
    v_add_f32 v29, v29, v34
    v_mfma_f32_16x16x32_bf16 v[84:87], a[140:143], a[52:55], v[84:87]
    v_exp_f32 v35, v125
    v_mfma_f32_16x16x32_bf16 v[92:95], a[136:139], a[56:59], v[92:95]
    ds_read_b64_tr_b16 a[136:137], v4 offset:36864
    ds_read_b64_tr_b16 a[138:139], v4 offset:43008
    v_add_f32 v29, v29, v35
    v_mfma_f32_16x16x32_bf16 v[92:95], a[140:143], a[60:63], v[92:95]
    ds_read_b64_tr_b16 a[140:141], v5 offset:36864
    ds_read_b64_tr_b16 a[142:143], v5 offset:43008
    v_mfma_f32_16x16x32_bf16 v[68:71], a[144:147], a[96:99], v[68:71]
    buffer_load_dwordx4 v10, s[4:7], s20 offen offset:2048 nt lds
    v_cvt_pk_bf16_f32 v62, v34, v35
    v_mfma_f32_16x16x32_bf16 v[68:71], a[148:151], a[100:103], v[68:71]
    s_add_u32 s20, s20, 12288
    v_exp_f32 v36, v126
    v_mfma_f32_16x16x32_bf16 v[76:79], a[144:147], a[104:107], v[76:79]
    v_exp_f32 v37, v127
    v_mfma_f32_16x16x32_bf16 v[76:79], a[148:151], a[108:111], v[76:79]
    v_add_f32 v29, v29, v36
    v_add_f32 v29, v29, v37
    v_cvt_pk_bf16_f32 v63, v36, v37
    v_mfma_f32_16x16x32_bf16 v[84:87], a[144:147], a[112:115], v[84:87]
    v_max_f32 v39, v39, v29
    v_cmp_nge_f32 vcc, 0x44800000, v39
    s_cbranch_vccnz Lrs7
Lrr8:
    v_mfma_f32_16x16x32_bf16 v[84:87], a[148:151], a[116:119], v[84:87]
    s_waitcnt lgkmcnt(6)
    v_add_f32 v22, v22, v26
    v_add_f32 v23, v23, v27
    v_mfma_f32_16x16x32_bf16 v[92:95], a[144:147], a[120:123], v[92:95]
    v_add_f32 v24, v24, v28
    v_add_f32 v25, v25, v29
    v_mfma_f32_16x16x32_bf16 v[92:95], a[148:151], a[124:127], v[92:95]
    v_mfma_f32_16x16x32_bf16 v[128:131], a[128:131], v[48:51], v[128:131]
    ds_read_b64_tr_b16 a[144:145], v2 offset:36992
    ds_read_b64_tr_b16 a[146:147], v2 offset:43136
    ds_read_b64_tr_b16 a[148:149], v3 offset:36992
    ds_read_b64_tr_b16 a[150:151], v3 offset:43136
    v_mov_b32 v26, v22
    v_mov_b32 v27, v23
    v_mov_b32 v28, v24
    v_mfma_f32_16x16x32_bf16 v[132:135], a[128:131], v[52:55], v[132:135]
    s_add_u32 m0, s22, 12288
    v_mov_b32 v29, v25
    v_mov_b32 v30, v26
    v_mov_b32 v31, v27
    v_mov_b32 v32, v28
    v_mov_b32 v33, v29
    v_permlane32_swap_b32 v30, v26
    v_permlane32_swap_b32 v31, v27
    v_mfma_f32_16x16x32_bf16 v[136:139], a[128:131], v[56:59], v[136:139]
    buffer_load_dwordx4 v8, s[8:11], s21 offen offset:0 nt lds
    v_permlane32_swap_b32 v32, v28
    v_permlane32_swap_b32 v33, v29
    v_add_f32 v26, v26, v30
    v_add_f32 v27, v27, v31
    v_add_f32 v28, v28, v32
    v_add_f32 v29, v29, v33
    v_mfma_f32_16x16x32_bf16 v[140:143], a[128:131], v[60:63], v[140:143]
    s_waitcnt lgkmcnt(8)
    ds_read_b64_tr_b16 a[128:129], v4 offset:36992
    ds_read_b64_tr_b16 a[130:131], v4 offset:43136
    v_mov_b32 v30, v26
    v_mov_b32 v31, v27
    v_mov_b32 v32, v28
    v_mov_b32 v33, v29
    v_permlane16_swap_b32 v30, v26
    v_mfma_f32_16x16x32_bf16 v[156:159], a[132:135], v[60:63], v[156:159]
    v_permlane16_swap_b32 v31, v27
    v_permlane16_swap_b32 v32, v28
    v_permlane16_swap_b32 v33, v29
    v_add_f32 v26, v26, v30
    v_add_f32 v27, v27, v31
    v_add_f32 v28, v28, v32
    v_add_f32 v29, v29, v33
    v_max3_f32 v18, v64, v65, v66
    v_mfma_f32_16x16x32_bf16 v[152:155], a[132:135], v[56:59], v[152:155]
    v_rcp_f32 v26, v26
    v_rcp_f32 v27, v27
    v_rcp_f32 v28, v28
    v_max3_f32 v19, v72, v73, v74
    v_mfma_f32_16x16x32_bf16 v[148:151], a[132:135], v[52:55], v[148:151]
    buffer_load_dwordx4 v9, s[8:11], s21 offen offset:1024 nt lds
    v_rcp_f32 v29, v29
    v_max3_f32 v20, v80, v81, v82
    v_mul_f32 v128, v128, v26
    v_mul_f32 v129, v129, v26
    v_mul_f32 v130, v130, v26
    v_mfma_f32_16x16x32_bf16 v[144:147], a[132:135], v[48:51], v[144:147]
    s_waitcnt lgkmcnt(8)
    ds_read_b64_tr_b16 a[132:133], v5 offset:36992
    ds_read_b64_tr_b16 a[134:135], v5 offset:43136
    v_mul_f32 v131, v131, v26
    v_mul_f32 v132, v132, v27
    v_max3_f32 v21, v88, v89, v90
    v_max3_f32 v18, v18, v67, v68
    v_mul_f32 v133, v133, v27
    v_mfma_f32_16x16x32_bf16 v[160:163], a[136:139], v[48:51], v[160:163]
    v_mul_f32 v134, v134, v27
    v_mul_f32 v135, v135, v27
    v_cvt_pk_bf16_f32 v128, v128, v129
    v_cvt_pk_bf16_f32 v129, v130, v131
    v_max3_f32 v19, v19, v75, v76
    v_max3_f32 v20, v20, v83, v84
    v_mul_f32 v136, v136, v28
    v_mul_f32 v137, v137, v28
    v_mfma_f32_16x16x32_bf16 v[164:167], a[136:139], v[52:55], v[164:167]
    ds_write_b64 v16, v[128:129] offset:0
    v_mul_f32 v138, v138, v28
    v_mul_f32 v139, v139, v28
    v_max3_f32 v21, v21, v91, v92
    v_max3_f32 v18, v18, v69, v70
    v_cvt_pk_bf16_f32 v132, v132, v133
    v_cvt_pk_bf16_f32 v133, v134, v135
    v_mfma_f32_16x16x32_bf16 v[168:171], a[136:139], v[56:59], v[168:171]
    buffer_load_dwordx4 v10, s[8:11], s21 offen offset:2048 nt lds
    ds_write_b64 v16, v[132:133] offset:2048
    v_mul_f32 v140, v140, v29
    v_mul_f32 v141, v141, v29
    v_max3_f32 v19, v19, v77, v78
    v_max3_f32 v20, v20, v85, v86
    v_max3_f32 v21, v21, v93, v94
    v_mfma_f32_16x16x32_bf16 v[172:175], a[136:139], v[60:63], v[172:175]
    s_waitcnt lgkmcnt(10)
    ds_read_b64_tr_b16 a[136:137], v2 offset:37120
    ds_read_b64_tr_b16 a[138:139], v2 offset:43264
    v_mul_f32 v142, v142, v29
    v_mul_f32 v143, v143, v29
    v_cvt_pk_bf16_f32 v136, v136, v137
    v_cvt_pk_bf16_f32 v137, v138, v139
    v_mul_f32 v144, v144, v26
    v_mfma_f32_16x16x32_bf16 v[188:191], a[140:143], v[60:63], v[188:191]
    s_add_u32 s21, s21, 12288
    ds_write_b64 v16, v[136:137] offset:4096
    v_max_f32 v18, v18, v71
    v_max_f32 v19, v19, v79
    v_mul_f32 v145, v145, v26
    v_mul_f32 v146, v146, v26
    v_mul_f32 v147, v147, v26
    v_cvt_pk_bf16_f32 v140, v140, v141
    v_max_f32 v20, v20, v87
    v_mfma_f32_16x16x32_bf16 v[184:187], a[140:143], v[56:59], v[184:187]
    v_max_f32 v21, v21, v95
    v_cvt_pk_bf16_f32 v141, v142, v143
    v_mul_f32 v148, v148, v27
    v_mul_f32 v149, v149, v27
    v_mov_b32 v34, v18
    v_mov_b32 v35, v19
    v_mul_f32 v150, v150, v27
    v_mfma_f32_16x16x32_bf16 v[180:183], a[140:143], v[52:55], v[180:183]
    ds_write_b64 v16, v[140:141] offset:6144
    v_mul_f32 v151, v151, v27
    v_cvt_pk_bf16_f32 v144, v144, v145
    v_cvt_pk_bf16_f32 v145, v146, v147
    v_xor_b32 v38, 32, v16
    v_mov_b32 v36, v20
    v_mov_b32 v37, v21
    v_mfma_f32_16x16x32_bf16 v[176:179], a[140:143], v[48:51], v[176:179]
    s_waitcnt lgkmcnt(12)
    ds_read_b64_tr_b16 a[140:141], v3 offset:37120
    ds_read_b64_tr_b16 a[142:143], v3 offset:43264
    ds_write_b64 v38, v[144:145] offset:0
    v_mul_f32 v152, v152, v28
    v_mul_f32 v153, v153, v28
    v_mul_f32 v154, v154, v28
    v_mul_f32 v155, v155, v28
    v_mfma_f32_16x16x32_bf16 v[192:195], a[144:147], v[48:51], v[192:195]
    v_permlane32_swap_b32 v34, v18
    v_permlane32_swap_b32 v35, v19
    v_permlane32_swap_b32 v36, v20
    v_cvt_pk_bf16_f32 v148, v148, v149
    v_cvt_pk_bf16_f32 v149, v150, v151
    v_mul_f32 v156, v156, v29
    v_mul_f32 v157, v157, v29
    v_permlane32_swap_b32 v37, v21
    v_mfma_f32_16x16x32_bf16 v[196:199], a[144:147], v[52:55], v[196:199]
    ds_write_b64 v38, v[148:149] offset:2048
    v_max_f32 v18, v18, v34
    v_mul_f32 v158, v158, v29
    v_mul_f32 v159, v159, v29
    v_cvt_pk_bf16_f32 v152, v152, v153
    v_cvt_pk_bf16_f32 v153, v154, v155
    v_mul_f32 v160, v160, v26
    v_mfma_f32_16x16x32_bf16 v[200:203], a[144:147], v[56:59], v[200:203]
    ds_write_b64 v38, v[152:153] offset:4096
    v_max_f32 v19, v19, v35
    v_max_f32 v20, v20, v36
    v_mul_f32 v161, v161, v26
    v_mul_f32 v162, v162, v26
    v_mul_f32 v163, v163, v26
    v_cvt_pk_bf16_f32 v156, v156, v157
    v_mfma_f32_16x16x32_bf16 v[204:207], a[144:147], v[60:63], v[204:207]
    s_waitcnt lgkmcnt(15)
    ds_read_b64_tr_b16 a[144:145], v4 offset:37120
    ds_read_b64_tr_b16 a[146:147], v4 offset:43264
    v_max_f32 v21, v21, v37
    v_mov_b32 v34, v18
    v_cvt_pk_bf16_f32 v157, v158, v159
    v_mul_f32 v164, v164, v27
    v_mul_f32 v165, v165, v27
    v_mfma_f32_16x16x32_bf16 v[220:223], a[148:151], v[60:63], v[220:223]
    ds_write_b64 v38, v[156:157] offset:6144
    v_mul_f32 v166, v166, v27
    v_mov_b32 v35, v19
    v_mov_b32 v36, v20
    v_mov_b32 v37, v21
    v_mul_f32 v167, v167, v27
    v_cvt_pk_bf16_f32 v160, v160, v161
    v_mfma_f32_16x16x32_bf16 v[216:219], a[148:151], v[56:59], v[216:219]
    v_cvt_pk_bf16_f32 v161, v162, v163
    v_xor_b32 v38, 64, v16
    v_permlane16_swap_b32 v34, v18
    v_permlane16_swap_b32 v35, v19
    v_mul_f32 v168, v168, v28
    v_mul_f32 v169, v169, v28
    v_mul_f32 v170, v170, v28
    v_mul_f32 v171, v171, v28
    v_mfma_f32_16x16x32_bf16 v[212:215], a[148:151], v[52:55], v[212:215]
    ds_write_b64 v38, v[160:161] offset:0
    v_permlane16_swap_b32 v36, v20
    v_permlane16_swap_b32 v37, v21
    v_cvt_pk_bf16_f32 v164, v164, v165
    v_cvt_pk_bf16_f32 v165, v166, v167
    v_mul_f32 v172, v172, v29
    v_mul_f32 v173, v173, v29
    v_mfma_f32_16x16x32_bf16 v[208:211], a[148:151], v[48:51], v[208:211]
    s_waitcnt lgkmcnt(15)
    ds_read_b64_tr_b16 a[148:149], v5 offset:37120
    ds_read_b64_tr_b16 a[150:151], v5 offset:43264
    ds_write_b64 v38, v[164:165] offset:2048
    v_xor_b32 v2, 0xc000, v2
    v_max_f32 v18, v18, v34
    v_max_f32 v19, v19, v35
    v_mul_f32 v174, v174, v29
    v_mfma_f32_16x16x32_bf16 v[224:227], a[128:131], v[48:51], v[224:227]
    v_mul_f32 v175, v175, v29
    v_cvt_pk_bf16_f32 v168, v168, v169
    v_cvt_pk_bf16_f32 v169, v170, v171
    v_mul_f32 v176, v176, v26
    v_xor_b32 v3, 0xc000, v3
    v_max_f32 v20, v20, v36
    v_max_f32 v21, v21, v37
    v_mfma_f32_16x16x32_bf16 v[228:231], a[128:131], v[52:55], v[228:231]
    ds_write_b64 v38, v[168:169] offset:4096
    v_mul_f32 v177, v177, v26
    v_mul_f32 v178, v178, v26
    v_mul_f32 v179, v179, v26
    v_cvt_pk_bf16_f32 v172, v172, v173
    v_xor_b32 v4, 0xc000, v4
    v_mul_f32 v18, s23, v18
    v_mul_f32 v19, s23, v19
    v_mfma_f32_16x16x32_bf16 v[232:235], a[128:131], v[56:59], v[232:235]
    v_mul_f32 v20, s23, v20
    v_cvt_pk_bf16_f32 v173, v174, v175
    v_mul_f32 v180, v180, v27
    v_mul_f32 v181, v181, v27
    v_mul_f32 v182, v182, v27
    v_xor_b32 v5, 0xc000, v5
    v_mul_f32 v21, s23, v21
    v_mfma_f32_16x16x32_bf16 v[236:239], a[128:131], v[60:63], v[236:239]
    s_waitcnt lgkmcnt(15)
    ds_read_b128 a[128:131], v0 offset:24576
    ds_write_b64 v38, v[172:173] offset:6144
    v_fma_f32 v64, v64, s23, -v18
    v_mul_f32 v183, v183, v27
    v_cvt_pk_bf16_f32 v176, v176, v177
    v_cvt_pk_bf16_f32 v177, v178, v179
    v_xor_b32 v38, 96, v16
    v_mfma_f32_16x16x32_bf16 v[252:255], a[132:135], v[60:63], v[252:255]
    ds_write_b64 v38, v[176:177] offset:0
    ds_read_b128 a[64:67], v17 offset:0
    v_fma_f32 v65, v65, s23, -v18
    v_fma_f32 v66, v66, s23, -v18
    v_mul_f32 v184, v184, v28
    v_mul_f32 v185, v185, v28
    v_mul_f32 v186, v186, v28
    v_mfma_f32_16x16x32_bf16 v[248:251], a[132:135], v[56:59], v[248:251]
    ds_read_b128 a[68:71], v17 offset:1024
    v_mul_f32 v187, v187, v28
    v_fma_f32 v67, v67, s23, -v18
    v_exp_f32 v34, v64
    v_cvt_pk_bf16_f32 v180, v180, v181
    v_cvt_pk_bf16_f32 v181, v182, v183
    v_mul_f32 v188, v188, v29
    v_mfma_f32_16x16x32_bf16 v[244:247], a[132:135], v[52:55], v[244:247]
    ds_write_b64 v38, v[180:181] offset:2048
    ds_read_b128 a[72:75], v17 offset:2048
    v_fma_f32 v68, v68, s23, -v18
    v_mul_f32 v189, v189, v29
    v_mul_f32 v190, v190, v29
    v_mul_f32 v191, v191, v29
    v_cvt_pk_bf16_f32 v184, v184, v185
    v_mfma_f32_16x16x32_bf16 v[240:243], a[132:135], v[48:51], v[240:243]
    s_waitcnt lgkmcnt(15)
    ds_read_b128 a[132:135], v1 offset:24576
    ds_read_b128 a[76:79], v17 offset:3072
    v_exp_f32 v35, v65
    v_fma_f32 v69, v69, s23, -v18
    v_cvt_pk_bf16_f32 v185, v186, v187
    v_mul_f32 v192, v192, v26
    v_mfma_f32_16x16x32_bf16 a[152:155], a[136:139], v[48:51], a[152:155]
    ds_write_b64 v38, v[184:185] offset:4096
    ds_read_b128 a[80:83], v17 offset:4096
    v_mul_f32 v193, v193, v26
    v_exp_f32 v36, v66
    v_mul_f32 v194, v194, v26
    v_mul_f32 v195, v195, v26
    v_mfma_f32_16x16x32_bf16 a[156:159], a[136:139], v[52:55], a[156:159]
    ds_read_b128 a[84:87], v17 offset:5120
    v_cvt_pk_bf16_f32 v188, v188, v189
    v_cvt_pk_bf16_f32 v189, v190, v191
    v_fma_f32 v70, v70, s23, -v18
    v_add_f32 v22, v34, v35
    v_mul_f32 v196, v196, v27
    v_mul_f32 v197, v197, v27
    v_cvt_pk_bf16_f32 v40, v34, v35
    v_mfma_f32_16x16x32_bf16 a[160:163], a[136:139], v[56:59], a[160:163]
    ds_write_b64 v38, v[188:189] offset:6144
    ds_read_b128 a[88:91], v17 offset:6144
    v_exp_f32 v37, v67
    v_mul_f32 v198, v198, v27
    v_mul_f32 v199, v199, v27
    v_cvt_pk_bf16_f32 v192, v192, v193
    v_mfma_f32_16x16x32_bf16 a[164:167], a[136:139], v[60:63], a[164:167]
    s_waitcnt lgkmcnt(15)
    ds_read_b128 a[136:139], v0 offset:24704
    ds_read_b128 a[92:95], v17 offset:7168
    v_cvt_pk_bf16_f32 v193, v194, v195
    v_fma_f32 v71, v71, s23, -v18
    v_add_f32 v22, v22, v36
    v_mul_f32 v200, v200, v28
    v_mul_f32 v201, v201, v28
    v_mfma_f32_16x16x32_bf16 a[180:183], a[140:143], v[60:63], a[180:183]
    ds_write_b64 v16, v[192:193] offset:8192
    v_exp_f32 v34, v68
    v_mul_f32 v202, v202, v28
    v_mul_f32 v203, v203, v28
    v_cvt_pk_bf16_f32 v196, v196, v197
    v_cvt_pk_bf16_f32 v197, v198, v199
    v_mfma_f32_16x16x32_bf16 a[176:179], a[140:143], v[56:59], a[176:179]
    ds_write_b64 v16, v[196:197] offset:10240
    v_mul_f32 v204, v204, v29
    v_fma_f32 v72, v72, s23, -v19
    v_add_f32 v22, v22, v37
    v_mul_f32 v205, v205, v29
    v_mul_f32 v206, v206, v29
    v_mul_f32 v207, v207, v29
    v_mfma_f32_16x16x32_bf16 a[172:175], a[140:143], v[52:55], a[172:175]
    v_cvt_pk_bf16_f32 v200, v200, v201
    v_cvt_pk_bf16_f32 v41, v36, v37
    v_exp_f32 v35, v69
    v_cvt_pk_bf16_f32 v201, v202, v203
    v_mul_f32 v208, v208, v26
    v_mul_f32 v209, v209, v26
    v_mul_f32 v210, v210, v26
    v_mfma_f32_16x16x32_bf16 a[168:171], a[140:143], v[48:51], a[168:171]
    s_waitcnt lgkmcnt(15)
    ds_read_b128 a[140:143], v1 offset:24704
    ds_write_b64 v16, v[200:201] offset:12288
    v_fma_f32 v73, v73, s23, -v19
    v_mul_f32 v211, v211, v26
    v_cvt_pk_bf16_f32 v204, v204, v205
    v_cvt_pk_bf16_f32 v205, v206, v207
    v_mul_f32 v212, v212, v27
    v_mfma_f32_16x16x32_bf16 a[184:187], a[144:147], v[48:51], a[184:187]
    ds_write_b64 v16, v[204:205] offset:14336
    v_mul_f32 v213, v213, v27
    v_add_f32 v22, v22, v34
    v_exp_f32 v36, v70
    v_mul_f32 v214, v214, v27
    v_mul_f32 v215, v215, v27
    v_mfma_f32_16x16x32_bf16 a[188:191], a[144:147], v[52:55], a[188:191]
    v_cvt_pk_bf16_f32 v208, v208, v209
    v_cvt_pk_bf16_f32 v209, v210, v211
    v_fma_f32 v74, v74, s23, -v19
    v_add_f32 v22, v22, v35
    v_xor_b32 v38, 32, v16
    v_mul_f32 v216, v216, v28
    v_mul_f32 v217, v217, v28
    v_mfma_f32_16x16x32_bf16 a[192:195], a[144:147], v[56:59], a[192:195]
    ds_write_b64 v38, v[208:209] offset:8192
    v_cvt_pk_bf16_f32 v42, v34, v35
    v_exp_f32 v37, v71
    v_mul_f32 v218, v218, v28
    v_mul_f32 v219, v219, v28
    v_cvt_pk_bf16_f32 v212, v212, v213
    v_cvt_pk_bf16_f32 v213, v214, v215
    v_mfma_f32_16x16x32_bf16 a[196:199], a[144:147], v[60:63], a[196:199]
    s_waitcnt lgkmcnt(15)
    ds_read_b128 a[144:147], v0 offset:24832
    ds_write_b64 v38, v[212:213] offset:10240
    v_mul_f32 v220, v220, v29
    v_fma_f32 v75, v75, s23, -v19
    v_mul_f32 v221, v221, v29
    v_mul_f32 v222, v222, v29
    v_mul_f32 v223, v223, v29
    v_mfma_f32_16x16x32_bf16 a[212:215], a[148:151], v[60:63], a[212:215]
    v_cvt_pk_bf16_f32 v216, v216, v217
    v_add_f32 v22, v22, v36
    v_add_f32 v22, v22, v37
    v_cvt_pk_bf16_f32 v43, v36, v37
    v_cvt_pk_bf16_f32 v217, v218, v219
    v_mul_f32 v224, v224, v26
    v_mul_f32 v225, v225, v26
    v_mfma_f32_16x16x32_bf16 a[208:211], a[148:151], v[56:59], a[208:211]
    ds_write_b64 v38, v[216:217] offset:12288
    v_mul_f32 v226, v226, v26
    v_exp_f32 v34, v72
    v_mul_f32 v227, v227, v26
    v_cvt_pk_bf16_f32 v220, v220, v221
    v_cvt_pk_bf16_f32 v221, v222, v223
    v_mfma_f32_16x16x32_bf16 a[204:207], a[148:151], v[52:55], a[204:207]
    ds_write_b64 v38, v[220:221] offset:14336
    v_mul_f32 v228, v228, v27
    v_mul_f32 v229, v229, v27
    v_fma_f32 v76, v76, s23, -v19
    v_exp_f32 v35, v73
    v_mul_f32 v230, v230, v27
    v_mul_f32 v231, v231, v27
    v_mfma_f32_16x16x32_bf16 a[200:203], a[148:151], v[48:51], a[200:203]
    s_waitcnt lgkmcnt(15)
    ds_read_b128 a[148:151], v1 offset:24832
    v_cvt_pk_bf16_f32 v224, v224, v225
    v_cvt_pk_bf16_f32 v225, v226, v227
    v_fma_f32 v77, v77, s23, -v19
    v_xor_b32 v38, 64, v16
    v_mul_f32 v232, v232, v28
    v_mul_f32 v233, v233, v28
    v_mfma_f32_16x16x32_bf16 v[96:99], a[128:131], a[0:3], 0
    s_waitcnt lgkmcnt(15)
    ds_write_b64 v38, v[224:225] offset:8192
    v_exp_f32 v36, v74
    v_mul_f32 v234, v234, v28
    v_mul_f32 v235, v235, v28
    v_cvt_pk_bf16_f32 v228, v228, v229
    v_cvt_pk_bf16_f32 v229, v230, v231
    v_mfma_f32_16x16x32_bf16 v[96:99], a[132:135], a[4:7], v[96:99]
    ds_write_b64 v38, v[228:229] offset:10240
    v_mul_f32 v236, v236, v29
    v_fma_f32 v78, v78, s23, -v19
    v_add_f32 v23, v34, v35
    v_cvt_pk_bf16_f32 v44, v34, v35
    v_mul_f32 v237, v237, v29
    v_mul_f32 v238, v238, v29
    v_mfma_f32_16x16x32_bf16 v[104:107], a[128:131], a[8:11], 0
    v_mul_f32 v239, v239, v29
    v_cvt_pk_bf16_f32 v232, v232, v233
    v_exp_f32 v37, v75
    v_cvt_pk_bf16_f32 v233, v234, v235
    v_mul_f32 v240, v240, v26
    v_mul_f32 v241, v241, v26
    v_mul_f32 v242, v242, v26
    v_mfma_f32_16x16x32_bf16 v[104:107], a[132:135], a[12:15], v[104:107]
    ds_write_b64 v38, v[232:233] offset:12288
    v_fma_f32 v79, v79, s23, -v19
    v_add_f32 v23, v23, v36
    v_mul_f32 v243, v243, v26
    v_cvt_pk_bf16_f32 v236, v236, v237
    v_cvt_pk_bf16_f32 v237, v238, v239
    v_mul_f32 v244, v244, v27
    v_mfma_f32_16x16x32_bf16 v[112:115], a[128:131], a[16:19], 0
    ds_write_b64 v38, v[236:237] offset:14336
    v_mul_f32 v245, v245, v27
    v_exp_f32 v34, v76
    v_mul_f32 v246, v246, v27
    v_mul_f32 v247, v247, v27
    v_cvt_pk_bf16_f32 v240, v240, v241
    v_mfma_f32_16x16x32_bf16 v[112:115], a[132:135], a[20:23], v[112:115]
    v_cvt_pk_bf16_f32 v241, v242, v243
    v_fma_f32 v80, v80, s23, -v20
    v_add_f32 v23, v23, v37
    v_xor_b32 v38, 96, v16
    v_mul_f32 v248, v248, v28
    v_mul_f32 v249, v249, v28
    v_mul_f32 v250, v250, v28
    v_mfma_f32_16x16x32_bf16 v[120:123], a[128:131], a[24:27], 0
    ds_read_b128 a[128:131], v0 offset:30720
    ds_write_b64 v38, v[240:241] offset:8192
    v_cvt_pk_bf16_f32 v45, v36, v37
    v_exp_f32 v35, v77
    v_mul_f32 v251, v251, v28
    v_cvt_pk_bf16_f32 v244, v244, v245
    v_cvt_pk_bf16_f32 v245, v246, v247
    v_mfma_f32_16x16x32_bf16 v[120:123], a[132:135], a[28:31], v[120:123]
    s_waitcnt lgkmcnt(15)
    ds_read_b128 a[132:135], v1 offset:30720
    ds_write_b64 v38, v[244:245] offset:10240
    v_mul_f32 v252, v252, v29
    v_fma_f32 v81, v81, s23, -v20
    v_add_f32 v23, v23, v34
    v_mul_f32 v253, v253, v29
    v_mul_f32 v254, v254, v29
    v_mfma_f32_16x16x32_bf16 v[96:99], a[136:139], a[32:35], v[96:99]
    s_waitcnt lgkmcnt(15)
    v_mul_f32 v255, v255, v29
    v_cvt_pk_bf16_f32 v248, v248, v249
    v_exp_f32 v36, v78
    v_cvt_pk_bf16_f32 v249, v250, v251
    v_accvgpr_read_b32 v128, a152
    v_accvgpr_read_b32 v129, a153
    v_mfma_f32_16x16x32_bf16 v[96:99], a[140:143], a[36:39], v[96:99]
    ds_write_b64 v38, v[248:249] offset:12288
    v_accvgpr_read_b32 v130, a154
    v_fma_f32 v82, v82, s23, -v20
    v_add_f32 v23, v23, v35
    v_accvgpr_read_b32 v131, a155
    v_mul_f32 v128, v128, v26
    v_mul_f32 v129, v129, v26
    v_mfma_f32_16x16x32_bf16 v[104:107], a[136:139], a[40:43], v[104:107]
    v_mul_f32 v130, v130, v26
    v_mul_f32 v131, v131, v26
    v_cvt_pk_bf16_f32 v46, v34, v35
    v_exp_f32 v37, v79
    v_cvt_pk_bf16_f32 v252, v252, v253
    v_cvt_pk_bf16_f32 v253, v254, v255
    v_mfma_f32_16x16x32_bf16 v[104:107], a[140:143], a[44:47], v[104:107]
    ds_write_b64 v38, v[252:253] offset:14336
    v_accvgpr_read_b32 v132, a156
    v_accvgpr_read_b32 v133, a157
    v_fma_f32 v83, v83, s23, -v20
    v_add_f32 v23, v23, v36
    v_accvgpr_read_b32 v134, a158
    v_accvgpr_read_b32 v135, a159
    v_mul_f32 v132, v132, v27
    v_mfma_f32_16x16x32_bf16 v[112:115], a[136:139], a[48:51], v[112:115]
    v_mul_f32 v133, v133, v27
    v_mul_f32 v134, v134, v27
    v_add_f32 v23, v23, v37
    v_cvt_pk_bf16_f32 v47, v36, v37
    v_mul_f32 v135, v135, v27
    v_cvt_pk_bf16_f32 v128, v128, v129
    v_cvt_pk_bf16_f32 v129, v130, v131
    v_mfma_f32_16x16x32_bf16 v[112:115], a[140:143], a[52:55], v[112:115]
    ds_write_b64 v16, v[128:129] offset:0
    v_accvgpr_read_b32 v136, a160
    v_exp_f32 v34, v80
    v_accvgpr_read_b32 v137, a161
    v_accvgpr_read_b32 v138, a162
    v_accvgpr_read_b32 v139, a163
    v_mfma_f32_16x16x32_bf16 v[120:123], a[136:139], a[56:59], v[120:123]
    ds_read_b128 a[136:139], v0 offset:30848
    v_mul_f32 v136, v136, v28
    v_fma_f32 v84, v84, s23, -v20
    v_exp_f32 v35, v81
    v_mul_f32 v137, v137, v28
    v_mul_f32 v138, v138, v28
    v_mfma_f32_16x16x32_bf16 v[120:123], a[140:143], a[60:63], v[120:123]
    s_waitcnt lgkmcnt(15)
    ds_read_b128 a[140:143], v1 offset:30848
    v_mul_f32 v139, v139, v28
    v_cvt_pk_bf16_f32 v132, v132, v133
    v_cvt_pk_bf16_f32 v133, v134, v135
    v_fma_f32 v85, v85, s23, -v20
    v_exp_f32 v36, v82
    v_accvgpr_read_b32 v140, a164
    v_mfma_f32_16x16x32_bf16 v[96:99], a[144:147], a[96:99], v[96:99]
    s_waitcnt lgkmcnt(13)
    ds_write_b64 v16, v[132:133] offset:2048
    v_accvgpr_read_b32 v141, a165
    v_accvgpr_read_b32 v142, a166
    v_accvgpr_read_b32 v143, a167
    v_fma_f32 v86, v86, s23, -v20
    v_mul_f32 v140, v140, v29
    v_mul_f32 v141, v141, v29
    v_mfma_f32_16x16x32_bf16 v[96:99], a[148:151], a[100:103], v[96:99]
    v_mul_f32 v142, v142, v29
    v_mul_f32 v143, v143, v29
    v_cvt_pk_bf16_f32 v136, v136, v137
    v_add_f32 v24, v34, v35
    v_cvt_pk_bf16_f32 v56, v34, v35
    v_cvt_pk_bf16_f32 v137, v138, v139
    v_accvgpr_read_b32 v144, a168
    v_mfma_f32_16x16x32_bf16 v[104:107], a[144:147], a[104:107], v[104:107]
    ds_write_b64 v16, v[136:137] offset:4096
    v_accvgpr_read_b32 v145, a169
    v_accvgpr_read_b32 v146, a170
    v_exp_f32 v37, v83
    v_accvgpr_read_b32 v147, a171
    v_mul_f32 v144, v144, v26
    v_mfma_f32_16x16x32_bf16 v[104:107], a[148:151], a[108:111], v[104:107]
    v_mul_f32 v145, v145, v26
    v_mul_f32 v146, v146, v26
    v_mul_f32 v147, v147, v26
    v_fma_f32 v87, v87, s23, -v20
    v_add_f32 v24, v24, v36
    v_exp_f32 v34, v84
    v_cvt_pk_bf16_f32 v140, v140, v141
    v_mfma_f32_16x16x32_bf16 v[112:115], a[144:147], a[112:115], v[112:115]
    v_cvt_pk_bf16_f32 v141, v142, v143
    v_accvgpr_read_b32 v148, a172
    v_accvgpr_read_b32 v149, a173
    v_fma_f32 v88, v88, s23, -v21
    v_accvgpr_read_b32 v150, a174
    v_accvgpr_read_b32 v151, a175
    v_mul_f32 v148, v148, v27
    v_mfma_f32_16x16x32_bf16 v[112:115], a[148:151], a[116:119], v[112:115]
    ds_write_b64 v16, v[140:141] offset:6144
    v_mul_f32 v149, v149, v27
    v_add_f32 v24, v24, v37
    v_cvt_pk_bf16_f32 v57, v36, v37
    v_mul_f32 v150, v150, v27
    v_mul_f32 v151, v151, v27
    v_cvt_pk_bf16_f32 v144, v144, v145
    v_mfma_f32_16x16x32_bf16 v[120:123], a[144:147], a[120:123], v[120:123]
    ds_read_b128 a[144:147], v0 offset:30976
    buffer_store_dwordx4 a[64:67], v12, s[16:19], s28 offen offset:0
    v_cvt_pk_bf16_f32 v145, v146, v147
    v_xor_b32 v38, 32, v16
    v_exp_f32 v35, v85
    v_accvgpr_read_b32 v152, a176
    v_mfma_f32_16x16x32_bf16 v[120:123], a[148:151], a[124:127], v[120:123]
    s_waitcnt lgkmcnt(12)
    ds_read_b128 a[148:151], v1 offset:30976
    ds_write_b64 v38, v[144:145] offset:0
    v_accvgpr_read_b32 v153, a177
    v_accvgpr_read_b32 v154, a178
    v_accvgpr_read_b32 v155, a179
    v_fma_f32 v89, v89, s23, -v21
    v_add_f32 v24, v24, v34
    v_mul_f32 v152, v152, v28
    v_mfma_f32_16x16x32_bf16 v[100:103], a[128:131], a[0:3], 0
    s_waitcnt lgkmcnt(12)
    v_mul_f32 v153, v153, v28
    v_mul_f32 v154, v154, v28
    v_mul_f32 v155, v155, v28
    v_cvt_pk_bf16_f32 v148, v148, v149
    v_xor_b32 v0, 0xc000, v0
    v_exp_f32 v36, v86
    v_mfma_f32_16x16x32_bf16 v[100:103], a[132:135], a[4:7], v[100:103]
    v_fma_f32 v90, v90, s23, -v21
    v_cvt_pk_bf16_f32 v149, v150, v151
    v_accvgpr_read_b32 v156, a180
    v_accvgpr_read_b32 v157, a181
    v_accvgpr_read_b32 v158, a182
    v_xor_b32 v1, 0xc000, v1
    v_add_f32 v24, v24, v35
    v_mfma_f32_16x16x32_bf16 v[108:111], a[128:131], a[8:11], 0
    ds_write_b64 v38, v[148:149] offset:2048
    v_cvt_pk_bf16_f32 v58, v34, v35
    v_accvgpr_read_b32 v159, a183
    v_mul_f32 v156, v156, v29
    v_mul_f32 v157, v157, v29
    v_mul_f32 v158, v158, v29
    v_mul_f32 v159, v159, v29
    v_mfma_f32_16x16x32_bf16 v[108:111], a[132:135], a[12:15], v[108:111]
    v_exp_f32 v37, v87
    v_cvt_pk_bf16_f32 v152, v152, v153
    v_cvt_pk_bf16_f32 v153, v154, v155
    v_accvgpr_read_b32 v160, a184
    v_accvgpr_read_b32 v161, a185
    v_fma_f32 v91, v91, s23, -v21
    v_add_f32 v24, v24, v36
    v_mfma_f32_16x16x32_bf16 v[116:119], a[128:131], a[16:19], 0
    ds_write_b64 v38, v[152:153] offset:4096
    v_accvgpr_read_b32 v162, a186
    v_accvgpr_read_b32 v163, a187
    v_mul_f32 v160, v160, v26
    v_mul_f32 v161, v161, v26
    v_add_f32 v24, v24, v37
    v_cvt_pk_bf16_f32 v59, v36, v37
    v_mfma_f32_16x16x32_bf16 v[116:119], a[132:135], a[20:23], v[116:119]
    s_waitcnt vmcnt(15) lgkmcnt(0)
    v_mul_f32 v162, v162, v26
    v_mul_f32 v163, v163, v26
    v_cvt_pk_bf16_f32 v156, v156, v157
    v_cvt_pk_bf16_f32 v157, v158, v159
    v_accvgpr_read_b32 v164, a188
    v_exp_f32 v34, v88
    v_mfma_f32_16x16x32_bf16 v[124:127], a[128:131], a[24:27], 0
    s_barrier
    ds_read_b64_tr_b16 a[128:129], v2 offset:12288
    ds_read_b64_tr_b16 a[130:131], v2 offset:18432
    ds_write_b64 v38, v[156:157] offset:6144
    v_fma_f32 v92, v92, s23, -v21
    v_accvgpr_read_b32 v165, a189
    v_accvgpr_read_b32 v166, a190
    v_accvgpr_read_b32 v167, a191
    v_mfma_f32_16x16x32_bf16 v[124:127], a[132:135], a[28:31], v[124:127]
    s_add_u32 m0, s22, 24576
    ds_read_b64_tr_b16 a[132:133], v3 offset:12288
    ds_read_b64_tr_b16 a[134:135], v3 offset:18432
    v_mul_f32 v164, v164, v27
    v_exp_f32 v35, v89
    v_mul_f32 v165, v165, v27
    v_mul_f32 v166, v166, v27
    v_mfma_f32_16x16x32_bf16 v[100:103], a[136:139], a[32:35], v[100:103]
    buffer_load_dwordx4 v8, s[4:7], s20 offen offset:0 nt lds
    v_mul_f32 v167, v167, v27
    v_cvt_pk_bf16_f32 v160, v160, v161
    v_cvt_pk_bf16_f32 v161, v162, v163
    v_fma_f32 v93, v93, s23, -v21
    v_exp_f32 v36, v90
    v_xor_b32 v38, 64, v16
    v_mfma_f32_16x16x32_bf16 v[100:103], a[140:143], a[36:39], v[100:103]
    ds_write_b64 v38, v[160:161] offset:0
    v_accvgpr_read_b32 v168, a192
    v_accvgpr_read_b32 v169, a193
    v_accvgpr_read_b32 v170, a194
    v_fma_f32 v94, v94, s23, -v21
    v_accvgpr_read_b32 v171, a195
    v_mul_f32 v168, v168, v28
    v_mfma_f32_16x16x32_bf16 v[108:111], a[136:139], a[40:43], v[108:111]
    v_mul_f32 v169, v169, v28
    v_mul_f32 v170, v170, v28
    v_add_f32 v25, v34, v35
    v_cvt_pk_bf16_f32 v60, v34, v35
    v_exp_f32 v37, v91
    v_mul_f32 v171, v171, v28
    v_mfma_f32_16x16x32_bf16 v[108:111], a[140:143], a[44:47], v[108:111]
    v_cvt_pk_bf16_f32 v164, v164, v165
    v_cvt_pk_bf16_f32 v165, v166, v167
    v_accvgpr_read_b32 v172, a196
    v_accvgpr_read_b32 v173, a197
    v_fma_f32 v95, v95, s23, -v21
    v_accvgpr_read_b32 v174, a198
    v_accvgpr_read_b32 v175, a199
    v_mfma_f32_16x16x32_bf16 v[116:119], a[136:139], a[48:51], v[116:119]
    ds_write_b64 v38, v[164:165] offset:2048
    buffer_load_dwordx4 v9, s[4:7], s20 offen offset:1024 nt lds
    v_mul_f32 v172, v172, v29
    v_mul_f32 v173, v173, v29
    v_add_f32 v25, v25, v36
    v_exp_f32 v34, v92
    v_mul_f32 v174, v174, v29
    v_mfma_f32_16x16x32_bf16 v[116:119], a[140:143], a[52:55], v[116:119]
    v_mul_f32 v175, v175, v29
    v_cvt_pk_bf16_f32 v168, v168, v169
    v_cvt_pk_bf16_f32 v169, v170, v171
    v_accvgpr_read_b32 v176, a200
    v_add_f32 v25, v25, v37
    v_accvgpr_read_b32 v177, a201
    v_accvgpr_read_b32 v178, a202
    v_mfma_f32_16x16x32_bf16 v[124:127], a[136:139], a[56:59], v[124:127]
    ds_write_b64 v38, v[168:169] offset:4096
    buffer_store_dwordx4 a[68:71], v12, s[16:19], s28 offen offset:3072
    ds_read_b64_tr_b16 a[136:137], v4 offset:12288
    ds_read_b64_tr_b16 a[138:139], v4 offset:18432
    v_accvgpr_read_b32 v179, a203
    v_mul_f32 v176, v176, v26
    v_cvt_pk_bf16_f32 v61, v36, v37
    v_mfma_f32_16x16x32_bf16 v[124:127], a[140:143], a[60:63], v[124:127]
    ds_read_b64_tr_b16 a[140:141], v5 offset:12288
    ds_read_b64_tr_b16 a[142:143], v5 offset:18432
    v_exp_f32 v35, v93
    v_mul_f32 v177, v177, v26
    v_mul_f32 v178, v178, v26
    v_mul_f32 v179, v179, v26
    v_mfma_f32_16x16x32_bf16 v[100:103], a[144:147], a[96:99], v[100:103]
    buffer_load_dwordx4 v10, s[4:7], s20 offen offset:2048 nt lds
    v_cvt_pk_bf16_f32 v172, v172, v173
    v_cvt_pk_bf16_f32 v173, v174, v175
    v_add_f32 v25, v25, v34
    v_exp_f32 v36, v94
    v_accvgpr_read_b32 v180, a204
    v_accvgpr_read_b32 v181, a205
    v_mfma_f32_16x16x32_bf16 v[100:103], a[148:151], a[100:103], v[100:103]
    s_add_u32 s20, s20, 12288
    ds_write_b64 v38, v[172:173] offset:6144
    v_accvgpr_read_b32 v182, a206
    v_accvgpr_read_b32 v183, a207
    v_add_f32 v25, v25, v35
    v_mul_f32 v180, v180, v27
    v_mul_f32 v181, v181, v27
    v_mul_f32 v182, v182, v27
    v_mfma_f32_16x16x32_bf16 v[108:111], a[144:147], a[104:107], v[108:111]
    v_mul_f32 v183, v183, v27
    v_cvt_pk_bf16_f32 v62, v34, v35
    v_exp_f32 v37, v95
    v_cvt_pk_bf16_f32 v176, v176, v177
    v_cvt_pk_bf16_f32 v177, v178, v179
    v_xor_b32 v38, 96, v16
    v_mfma_f32_16x16x32_bf16 v[108:111], a[148:151], a[108:111], v[108:111]
    ds_write_b64 v38, v[176:177] offset:0
    v_accvgpr_read_b32 v184, a208
    v_accvgpr_read_b32 v185, a209
    v_add_f32 v25, v25, v36
    v_accvgpr_read_b32 v186, a210
    v_accvgpr_read_b32 v187, a211
    v_mul_f32 v184, v184, v28
    v_mfma_f32_16x16x32_bf16 v[116:119], a[144:147], a[112:115], v[116:119]
    v_mul_f32 v185, v185, v28
    v_add_f32 v25, v25, v37
    v_cvt_pk_bf16_f32 v63, v36, v37
    v_mul_f32 v186, v186, v28
    v_mul_f32 v187, v187, v28
    v_cvt_pk_bf16_f32 v180, v180, v181
    v_cvt_pk_bf16_f32 v181, v182, v183
    v_accvgpr_read_b32 v188, a212
    v_mfma_f32_16x16x32_bf16 v[116:119], a[148:151], a[116:119], v[116:119]
    s_waitcnt lgkmcnt(12)
    ds_write_b64 v38, v[180:181] offset:2048
    v_accvgpr_read_b32 v189, a213
    v_accvgpr_read_b32 v190, a214
    v_accvgpr_read_b32 v191, a215
    v_mul_f32 v188, v188, v29
    v_mul_f32 v189, v189, v29
    v_mul_f32 v190, v190, v29
    v_mfma_f32_16x16x32_bf16 v[124:127], a[144:147], a[120:123], v[124:127]
    v_mul_f32 v191, v191, v29
    v_cvt_pk_bf16_f32 v184, v184, v185
    v_cvt_pk_bf16_f32 v185, v186, v187
    v_cvt_pk_bf16_f32 v188, v188, v189
    v_cvt_pk_bf16_f32 v189, v190, v191
    v_mfma_f32_16x16x32_bf16 v[124:127], a[148:151], a[124:127], v[124:127]
    ds_write_b64 v38, v[184:185] offset:4096
    ds_write_b64 v38, v[188:189] offset:6144
    v_mfma_f32_16x16x32_bf16 v[128:131], a[128:131], v[40:43], 0
    ds_read_b64_tr_b16 a[144:145], v2 offset:12416
    ds_read_b64_tr_b16 a[146:147], v2 offset:18560
    v_mfma_f32_16x16x32_bf16 v[132:135], a[128:131], v[44:47], 0
    s_add_u32 m0, s22, 36864
    ds_read_b64_tr_b16 a[148:149], v3 offset:12416
    ds_read_b64_tr_b16 a[150:151], v3 offset:18560
    v_mfma_f32_16x16x32_bf16 v[136:139], a[128:131], v[56:59], 0
    buffer_load_dwordx4 v8, s[8:11], s21 offen offset:0 nt lds
    ds_read_b128 a[216:219], v17 offset:14336
    v_mfma_f32_16x16x32_bf16 v[140:143], a[128:131], v[60:63], 0
    s_waitcnt lgkmcnt(15)
    ds_read_b64_tr_b16 a[128:129], v4 offset:12416
    ds_read_b64_tr_b16 a[130:131], v4 offset:18560
    v_mfma_f32_16x16x32_bf16 v[156:159], a[132:135], v[60:63], 0
    v_fma_f32 v96, v96, s23, -v18
    v_fma_f32 v97, v97, s23, -v18
    v_mfma_f32_16x16x32_bf16 v[152:155], a[132:135], v[56:59], 0
    v_fma_f32 v98, v98, s23, -v18
    v_fma_f32 v99, v99, s23, -v18
    v_mfma_f32_16x16x32_bf16 v[148:151], a[132:135], v[44:47], 0
    buffer_load_dwordx4 v9, s[8:11], s21 offen offset:1024 nt lds
    v_fma_f32 v100, v100, s23, -v18
    v_mfma_f32_16x16x32_bf16 v[144:147], a[132:135], v[40:43], 0
    s_waitcnt lgkmcnt(14)
    ds_read_b64_tr_b16 a[132:133], v5 offset:12416
    ds_read_b64_tr_b16 a[134:135], v5 offset:18560
    v_mfma_f32_16x16x32_bf16 v[160:163], a[136:139], v[40:43], 0
    v_exp_f32 v34, v96
    v_mfma_f32_16x16x32_bf16 v[164:167], a[136:139], v[44:47], 0
    v_exp_f32 v35, v97
    v_mfma_f32_16x16x32_bf16 v[168:171], a[136:139], v[56:59], 0
    buffer_load_dwordx4 v10, s[8:11], s21 offen offset:2048 nt lds
    v_fma_f32 v101, v101, s23, -v18
    v_mfma_f32_16x16x32_bf16 v[172:175], a[136:139], v[60:63], 0
    s_waitcnt lgkmcnt(14)
    ds_read_b64_tr_b16 a[136:137], v2 offset:12544
    ds_read_b64_tr_b16 a[138:139], v2 offset:18688
    v_mfma_f32_16x16x32_bf16 v[188:191], a[140:143], v[60:63], 0
    s_add_u32 s21, s21, 12288
    v_exp_f32 v36, v98
    v_mfma_f32_16x16x32_bf16 v[184:187], a[140:143], v[56:59], 0
    v_fma_f32 v102, v102, s23, -v18
    v_add_f32 v26, v34, v35
    v_mfma_f32_16x16x32_bf16 v[180:183], a[140:143], v[44:47], 0
    s_xor_b32 s22, s22, 0xc000
    v_cvt_pk_bf16_f32 v48, v34, v35
    v_exp_f32 v37, v99
    v_mfma_f32_16x16x32_bf16 v[176:179], a[140:143], v[40:43], 0
    s_waitcnt lgkmcnt(9)
    ds_read_b64_tr_b16 a[140:141], v3 offset:12544
    ds_read_b64_tr_b16 a[142:143], v3 offset:18688
    v_mfma_f32_16x16x32_bf16 v[192:195], a[144:147], v[40:43], 0
    buffer_store_dwordx4 a[72:75], v12, s[16:19], s29 offen offset:0
    v_fma_f32 v103, v103, s23, -v18
    v_mfma_f32_16x16x32_bf16 v[196:199], a[144:147], v[44:47], 0
    v_add_f32 v26, v26, v36
    v_fma_f32 v104, v104, s23, -v19
    v_mfma_f32_16x16x32_bf16 v[200:203], a[144:147], v[56:59], 0
    v_exp_f32 v34, v100
    v_mfma_f32_16x16x32_bf16 v[204:207], a[144:147], v[60:63], 0
    s_waitcnt lgkmcnt(9)
    ds_read_b64_tr_b16 a[144:145], v4 offset:12544
    ds_read_b64_tr_b16 a[146:147], v4 offset:18688
    v_mfma_f32_16x16x32_bf16 v[220:223], a[148:151], v[60:63], 0
    v_add_f32 v26, v26, v37
    v_cvt_pk_bf16_f32 v49, v36, v37
    v_mfma_f32_16x16x32_bf16 v[216:219], a[148:151], v[56:59], 0
    v_exp_f32 v35, v101
    v_mfma_f32_16x16x32_bf16 v[212:215], a[148:151], v[44:47], 0
    ds_read_b128 a[220:223], v17 offset:6144
    v_fma_f32 v105, v105, s23, -v19
    v_mfma_f32_16x16x32_bf16 v[208:211], a[148:151], v[40:43], 0
    s_waitcnt lgkmcnt(9)
    ds_read_b64_tr_b16 a[148:149], v5 offset:12544
    ds_read_b64_tr_b16 a[150:151], v5 offset:18688
    v_mfma_f32_16x16x32_bf16 v[224:227], a[128:131], v[40:43], 0
    v_add_f32 v26, v26, v34
    v_fma_f32 v106, v106, s23, -v19
    v_mfma_f32_16x16x32_bf16 v[228:231], a[128:131], v[44:47], 0
    v_exp_f32 v36, v102
    v_mfma_f32_16x16x32_bf16 v[232:235], a[128:131], v[56:59], 0
    v_add_f32 v26, v26, v35
    v_cvt_pk_bf16_f32 v50, v34, v35
    v_mfma_f32_16x16x32_bf16 v[236:239], a[128:131], v[60:63], 0
    s_waitcnt lgkmcnt(9)
    ds_read_b128 a[128:131], v0 offset:0
    v_fma_f32 v107, v107, s23, -v19
    v_mfma_f32_16x16x32_bf16 v[252:255], a[132:135], v[60:63], 0
    v_exp_f32 v37, v103
    v_mfma_f32_16x16x32_bf16 v[248:251], a[132:135], v[56:59], 0
    v_add_f32 v26, v26, v36
    v_add_f32 v26, v26, v37
    v_cvt_pk_bf16_f32 v51, v36, v37
    v_mfma_f32_16x16x32_bf16 v[244:247], a[132:135], v[44:47], 0
    buffer_store_dwordx4 a[216:219], v12, s[16:19], s31 offen offset:128
    v_fma_f32 v108, v108, s23, -v19
    v_mfma_f32_16x16x32_bf16 v[240:243], a[132:135], v[40:43], 0
    s_waitcnt lgkmcnt(8)
    ds_read_b128 a[132:135], v1 offset:0
    v_fma_f32 v109, v109, s23, -v19
    v_mfma_f32_16x16x32_bf16 a[152:155], a[136:139], v[40:43], 0
    v_exp_f32 v34, v104
    v_mfma_f32_16x16x32_bf16 a[156:159], a[136:139], v[44:47], 0
    v_exp_f32 v35, v105
    v_mfma_f32_16x16x32_bf16 a[160:163], a[136:139], v[56:59], 0
    v_exp_f32 v36, v106
    v_mfma_f32_16x16x32_bf16 a[164:167], a[136:139], v[60:63], 0
    s_waitcnt lgkmcnt(7)
    ds_read_b128 a[136:139], v0 offset:128
    v_fma_f32 v110, v110, s23, -v19
    v_mfma_f32_16x16x32_bf16 a[180:183], a[140:143], v[60:63], 0
    v_add_f32 v27, v34, v35
    v_cvt_pk_bf16_f32 v52, v34, v35
    v_mfma_f32_16x16x32_bf16 a[176:179], a[140:143], v[56:59], 0
    v_exp_f32 v37, v107
    v_mfma_f32_16x16x32_bf16 a[172:175], a[140:143], v[44:47], 0
    v_fma_f32 v111, v111, s23, -v19
    v_add_f32 v27, v27, v36
    v_mfma_f32_16x16x32_bf16 a[168:171], a[140:143], v[40:43], 0
    s_waitcnt lgkmcnt(6)
    ds_read_b128 a[140:143], v1 offset:128
    v_fma_f32 v112, v112, s23, -v20
    v_mfma_f32_16x16x32_bf16 a[184:187], a[144:147], v[40:43], 0
    v_exp_f32 v34, v108
    v_mfma_f32_16x16x32_bf16 a[188:191], a[144:147], v[44:47], 0
    v_add_f32 v27, v27, v37
    v_cvt_pk_bf16_f32 v53, v36, v37
    v_mfma_f32_16x16x32_bf16 a[192:195], a[144:147], v[56:59], 0
    v_exp_f32 v35, v109
    v_mfma_f32_16x16x32_bf16 a[196:199], a[144:147], v[60:63], 0
    s_waitcnt lgkmcnt(4)
    ds_read_b128 a[144:147], v0 offset:256
    v_fma_f32 v113, v113, s23, -v20
    v_add_f32 v27, v27, v34
    v_mfma_f32_16x16x32_bf16 a[212:215], a[148:151], v[60:63], 0
    buffer_store_dwordx4 a[76:79], v12, s[16:19], s29 offen offset:3072
    v_fma_f32 v114, v114, s23, -v20
    v_mfma_f32_16x16x32_bf16 a[208:211], a[148:151], v[56:59], 0
    v_exp_f32 v36, v110
    v_mfma_f32_16x16x32_bf16 a[204:207], a[148:151], v[44:47], 0
    v_add_f32 v27, v27, v35
    v_cvt_pk_bf16_f32 v54, v34, v35
    v_mfma_f32_16x16x32_bf16 a[200:203], a[148:151], v[40:43], 0
    s_waitcnt lgkmcnt(4)
    ds_read_b128 a[148:151], v1 offset:256
    v_fma_f32 v115, v115, s23, -v20
    v_mfma_f32_16x16x32_bf16 v[64:67], a[128:131], a[0:3], 0
    s_waitcnt lgkmcnt(4)
    v_exp_f32 v37, v111
    v_mfma_f32_16x16x32_bf16 v[64:67], a[132:135], a[4:7], v[64:67]
    v_add_f32 v27, v27, v36
    v_add_f32 v27, v27, v37
    v_mfma_f32_16x16x32_bf16 v[72:75], a[128:131], a[8:11], 0
    v_cvt_pk_bf16_f32 v55, v36, v37
    v_fma_f32 v116, v116, s23, -v20
    v_mfma_f32_16x16x32_bf16 v[72:75], a[132:135], a[12:15], v[72:75]
    v_exp_f32 v34, v112
    v_mfma_f32_16x16x32_bf16 v[80:83], a[128:131], a[16:19], 0
    v_exp_f32 v35, v113
    v_mfma_f32_16x16x32_bf16 v[80:83], a[132:135], a[20:23], v[80:83]
    v_fma_f32 v117, v117, s23, -v20
    v_fma_f32 v118, v118, s23, -v20
    v_mfma_f32_16x16x32_bf16 v[88:91], a[128:131], a[24:27], 0
    ds_read_b128 a[128:131], v0 offset:6144
    v_add_f32 v28, v34, v35
    v_mfma_f32_16x16x32_bf16 v[88:91], a[132:135], a[28:31], v[88:91]
    s_waitcnt lgkmcnt(4)
    ds_read_b128 a[132:135], v1 offset:6144
    v_cvt_pk_bf16_f32 v56, v34, v35
    v_mfma_f32_16x16x32_bf16 v[64:67], a[136:139], a[32:35], v[64:67]
    s_waitcnt lgkmcnt(4)
    v_exp_f32 v36, v114
    v_mfma_f32_16x16x32_bf16 v[64:67], a[140:143], a[36:39], v[64:67]
    v_exp_f32 v37, v115
    v_mfma_f32_16x16x32_bf16 v[72:75], a[136:139], a[40:43], v[72:75]
    buffer_store_dwordx4 a[220:223], v12, s[16:19], s31 offen offset:256
    v_fma_f32 v119, v119, s23, -v20
    v_add_f32 v28, v28, v36
    v_mfma_f32_16x16x32_bf16 v[72:75], a[140:143], a[44:47], v[72:75]
    v_exp_f32 v34, v116
    v_mfma_f32_16x16x32_bf16 v[80:83], a[136:139], a[48:51], v[80:83]
    v_fma_f32 v120, v120, s23, -v21
    v_add_f32 v28, v28, v37
    v_mfma_f32_16x16x32_bf16 v[80:83], a[140:143], a[52:55], v[80:83]
    v_cvt_pk_bf16_f32 v57, v36, v37
    v_fma_f32 v121, v121, s23, -v21
    v_mfma_f32_16x16x32_bf16 v[88:91], a[136:139], a[56:59], v[88:91]
    ds_read_b128 a[136:139], v0 offset:6272
    v_add_f32 v28, v28, v34
    v_mfma_f32_16x16x32_bf16 v[88:91], a[140:143], a[60:63], v[88:91]
    s_waitcnt lgkmcnt(4)
    ds_read_b128 a[140:143], v1 offset:6272
    v_fma_f32 v122, v122, s23, -v21
    v_mfma_f32_16x16x32_bf16 v[64:67], a[144:147], a[96:99], v[64:67]
    s_waitcnt lgkmcnt(4)
    v_exp_f32 v35, v117
    v_mfma_f32_16x16x32_bf16 v[64:67], a[148:151], a[100:103], v[64:67]
    v_exp_f32 v36, v118
    v_mfma_f32_16x16x32_bf16 v[72:75], a[144:147], a[104:107], v[72:75]
    v_add_f32 v28, v28, v35
    v_cvt_pk_bf16_f32 v58, v34, v35
    v_mfma_f32_16x16x32_bf16 v[72:75], a[148:151], a[108:111], v[72:75]
    v_exp_f32 v37, v119
    v_mfma_f32_16x16x32_bf16 v[80:83], a[144:147], a[112:115], v[80:83]
    v_fma_f32 v123, v123, s23, -v21
    v_add_f32 v28, v28, v36
    v_mfma_f32_16x16x32_bf16 v[80:83], a[148:151], a[116:119], v[80:83]
    v_add_f32 v28, v28, v37
    v_cvt_pk_bf16_f32 v59, v36, v37
    v_mfma_f32_16x16x32_bf16 v[88:91], a[144:147], a[120:123], v[88:91]
    ds_read_b128 a[144:147], v0 offset:6400
    v_fma_f32 v124, v124, s23, -v21
    v_mfma_f32_16x16x32_bf16 v[88:91], a[148:151], a[124:127], v[88:91]
    s_waitcnt lgkmcnt(4)
    ds_read_b128 a[148:151], v1 offset:6400
    v_fma_f32 v125, v125, s23, -v21
    v_mfma_f32_16x16x32_bf16 v[68:71], a[128:131], a[0:3], 0
    s_waitcnt lgkmcnt(4)
    buffer_store_dwordx4 a[80:83], v12, s[16:19], s30 offen offset:0
    v_exp_f32 v34, v120
    v_mfma_f32_16x16x32_bf16 v[68:71], a[132:135], a[4:7], v[68:71]
    v_exp_f32 v35, v121
    v_mfma_f32_16x16x32_bf16 v[76:79], a[128:131], a[8:11], 0
    v_exp_f32 v36, v122
    v_mfma_f32_16x16x32_bf16 v[76:79], a[132:135], a[12:15], v[76:79]
    v_fma_f32 v126, v126, s23, -v21
    v_add_f32 v29, v34, v35
    v_mfma_f32_16x16x32_bf16 v[84:87], a[128:131], a[16:19], 0
    v_cvt_pk_bf16_f32 v60, v34, v35
    v_fma_f32 v127, v127, s23, -v21
    v_mfma_f32_16x16x32_bf16 v[84:87], a[132:135], a[20:23], v[84:87]
    s_waitcnt vmcnt(19) lgkmcnt(0)
    v_exp_f32 v37, v123
    v_mfma_f32_16x16x32_bf16 v[92:95], a[128:131], a[24:27], 0
    s_barrier
    ds_read_b64_tr_b16 a[128:129], v2 offset:36864
    ds_read_b64_tr_b16 a[130:131], v2 offset:43008
    v_mfma_f32_16x16x32_bf16 v[92:95], a[132:135], a[28:31], v[92:95]
    s_add_u32 m0, s22, 0
    ds_read_b64_tr_b16 a[132:133], v3 offset:36864
    ds_read_b64_tr_b16 a[134:135], v3 offset:43008
    v_mfma_f32_16x16x32_bf16 v[68:71], a[136:139], a[32:35], v[68:71]
    buffer_load_dwordx4 v8, s[4:7], s20 offen offset:0 nt lds
    v_add_f32 v29, v29, v36
    v_mfma_f32_16x16x32_bf16 v[68:71], a[140:143], a[36:39], v[68:71]
    v_exp_f32 v34, v124
    v_mfma_f32_16x16x32_bf16 v[76:79], a[136:139], a[40:43], v[76:79]
    v_add_f32 v29, v29, v37
    v_cvt_pk_bf16_f32 v61, v36, v37
    v_mfma_f32_16x16x32_bf16 v[76:79], a[140:143], a[44:47], v[76:79]
    v_exp_f32 v35, v125
    v_mfma_f32_16x16x32_bf16 v[84:87], a[136:139], a[48:51], v[84:87]
    buffer_load_dwordx4 v9, s[4:7], s20 offen offset:1024 nt lds
    v_add_f32 v29, v29, v34
    v_mfma_f32_16x16x32_bf16 v[84:87], a[140:143], a[52:55], v[84:87]
    v_exp_f32 v36, v126
    v_mfma_f32_16x16x32_bf16 v[92:95], a[136:139], a[56:59], v[92:95]
    ds_read_b64_tr_b16 a[136:137], v4 offset:36864
    ds_read_b64_tr_b16 a[138:139], v4 offset:43008
    v_mfma_f32_16x16x32_bf16 v[92:95], a[140:143], a[60:63], v[92:95]
    ds_read_b64_tr_b16 a[140:141], v5 offset:36864
    ds_read_b64_tr_b16 a[142:143], v5 offset:43008
    v_add_f32 v29, v29, v35
    v_mfma_f32_16x16x32_bf16 v[68:71], a[144:147], a[96:99], v[68:71]
    buffer_load_dwordx4 v10, s[4:7], s20 offen offset:2048 nt lds
    v_cvt_pk_bf16_f32 v62, v34, v35
    v_mfma_f32_16x16x32_bf16 v[68:71], a[148:151], a[100:103], v[68:71]
    s_add_u32 s20, s20, 12288
    v_exp_f32 v37, v127
    v_mfma_f32_16x16x32_bf16 v[76:79], a[144:147], a[104:107], v[76:79]
    v_add_f32 v29, v29, v36
    v_add_f32 v29, v29, v37
    v_mfma_f32_16x16x32_bf16 v[76:79], a[148:151], a[108:111], v[76:79]
    v_cvt_pk_bf16_f32 v63, v36, v37
    v_max3_f32 v39, v26, v27, v28
    v_mfma_f32_16x16x32_bf16 v[84:87], a[144:147], a[112:115], v[84:87]
    v_max_f32 v39, v39, v29
    v_cmp_nge_f32 vcc, 0x44800000, v39
    s_cbranch_vccnz Lrs9
Lrr10:
    v_mfma_f32_16x16x32_bf16 v[84:87], a[148:151], a[116:119], v[84:87]
    s_waitcnt lgkmcnt(6)
    v_add_f32 v22, v22, v26
    v_add_f32 v23, v23, v27
    v_mfma_f32_16x16x32_bf16 v[92:95], a[144:147], a[120:123], v[92:95]
    v_add_f32 v24, v24, v28
    v_add_f32 v25, v25, v29
    v_mfma_f32_16x16x32_bf16 v[92:95], a[148:151], a[124:127], v[92:95]
    v_mfma_f32_16x16x32_bf16 v[128:131], a[128:131], v[48:51], v[128:131]
    ds_read_b64_tr_b16 a[144:145], v2 offset:36992
    ds_read_b64_tr_b16 a[146:147], v2 offset:43136
    v_mfma_f32_16x16x32_bf16 v[132:135], a[128:131], v[52:55], v[132:135]
    s_add_u32 m0, s22, 12288
    ds_read_b64_tr_b16 a[148:149], v3 offset:36992
    ds_read_b64_tr_b16 a[150:151], v3 offset:43136
    v_mfma_f32_16x16x32_bf16 v[136:139], a[128:131], v[56:59], v[136:139]
    buffer_load_dwordx4 v8, s[8:11], s21 offen offset:0 nt lds
    ds_read_b128 a[216:219], v17 offset:15360
    v_mfma_f32_16x16x32_bf16 v[140:143], a[128:131], v[60:63], v[140:143]
    s_waitcnt lgkmcnt(9)
    ds_read_b64_tr_b16 a[128:129], v4 offset:36992
    ds_read_b64_tr_b16 a[130:131], v4 offset:43136
    v_mfma_f32_16x16x32_bf16 v[156:159], a[132:135], v[60:63], v[156:159]
    v_fma_f32 v64, v64, s23, -v18
    v_fma_f32 v65, v65, s23, -v18
    v_mfma_f32_16x16x32_bf16 v[152:155], a[132:135], v[56:59], v[152:155]
    v_fma_f32 v66, v66, s23, -v18
    v_fma_f32 v67, v67, s23, -v18
    v_mfma_f32_16x16x32_bf16 v[148:151], a[132:135], v[52:55], v[148:151]
    buffer_load_dwordx4 v9, s[8:11], s21 offen offset:1024 nt lds
    v_fma_f32 v68, v68, s23, -v18
    v_mfma_f32_16x16x32_bf16 v[144:147], a[132:135], v[48:51], v[144:147]
    s_waitcnt lgkmcnt(9)
    ds_read_b64_tr_b16 a[132:133], v5 offset:36992
    ds_read_b64_tr_b16 a[134:135], v5 offset:43136
    v_fma_f32 v69, v69, s23, -v18
    v_mfma_f32_16x16x32_bf16 v[160:163], a[136:139], v[48:51], v[160:163]
    v_exp_f32 v34, v64
    v_mfma_f32_16x16x32_bf16 v[164:167], a[136:139], v[52:55], v[164:167]
    v_exp_f32 v35, v65
    v_mfma_f32_16x16x32_bf16 v[168:171], a[136:139], v[56:59], v[168:171]
    buffer_load_dwordx4 v10, s[8:11], s21 offen offset:2048 nt lds
    v_fma_f32 v70, v70, s23, -v18
    v_mfma_f32_16x16x32_bf16 v[172:175], a[136:139], v[60:63], v[172:175]
    s_waitcnt lgkmcnt(9)
    ds_read_b64_tr_b16 a[136:137], v2 offset:37120
    ds_read_b64_tr_b16 a[138:139], v2 offset:43264
    v_mfma_f32_16x16x32_bf16 v[188:191], a[140:143], v[60:63], v[188:191]
    s_add_u32 s21, s21, 12288
    v_exp_f32 v36, v66
    v_mfma_f32_16x16x32_bf16 v[184:187], a[140:143], v[56:59], v[184:187]
    v_add_f32 v26, v34, v35
    v_cvt_pk_bf16_f32 v40, v34, v35
    v_mfma_f32_16x16x32_bf16 v[180:183], a[140:143], v[52:55], v[180:183]
    v_exp_f32 v37, v67
    v_mfma_f32_16x16x32_bf16 v[176:179], a[140:143], v[48:51], v[176:179]
    s_waitcnt lgkmcnt(9)
    ds_read_b64_tr_b16 a[140:141], v3 offset:37120
    ds_read_b64_tr_b16 a[142:143], v3 offset:43264
    v_fma_f32 v71, v71, s23, -v18
    v_mfma_f32_16x16x32_bf16 v[192:195], a[144:147], v[48:51], v[192:195]
    buffer_store_dwordx4 a[84:87], v12, s[16:19], s30 offen offset:3072
    v_add_f32 v26, v26, v36
    v_mfma_f32_16x16x32_bf16 v[196:199], a[144:147], v[52:55], v[196:199]
    v_exp_f32 v34, v68
    v_mfma_f32_16x16x32_bf16 v[200:203], a[144:147], v[56:59], v[200:203]
    v_fma_f32 v72, v72, s23, -v19
    v_add_f32 v26, v26, v37
    v_mfma_f32_16x16x32_bf16 v[204:207], a[144:147], v[60:63], v[204:207]
    s_waitcnt lgkmcnt(9)
    ds_read_b64_tr_b16 a[144:145], v4 offset:37120
    ds_read_b64_tr_b16 a[146:147], v4 offset:43264
    v_mfma_f32_16x16x32_bf16 v[220:223], a[148:151], v[60:63], v[220:223]
    v_cvt_pk_bf16_f32 v41, v36, v37
    v_fma_f32 v73, v73, s23, -v19
    v_mfma_f32_16x16x32_bf16 v[216:219], a[148:151], v[56:59], v[216:219]
    v_exp_f32 v35, v69
    v_mfma_f32_16x16x32_bf16 v[212:215], a[148:151], v[52:55], v[212:215]
    ds_read_b128 a[220:223], v17 offset:7168
    v_add_f32 v26, v26, v34
    v_fma_f32 v74, v74, s23, -v19
    v_mfma_f32_16x16x32_bf16 v[208:211], a[148:151], v[48:51], v[208:211]
    s_waitcnt lgkmcnt(9)
    ds_read_b64_tr_b16 a[148:149], v5 offset:37120
    ds_read_b64_tr_b16 a[150:151], v5 offset:43264
    v_mfma_f32_16x16x32_bf16 v[224:227], a[128:131], v[48:51], v[224:227]
    v_exp_f32 v36, v70
    v_mfma_f32_16x16x32_bf16 v[228:231], a[128:131], v[52:55], v[228:231]
    v_add_f32 v26, v26, v35
    v_cvt_pk_bf16_f32 v42, v34, v35
    v_mfma_f32_16x16x32_bf16 v[232:235], a[128:131], v[56:59], v[232:235]
    v_exp_f32 v37, v71
    v_mfma_f32_16x16x32_bf16 v[236:239], a[128:131], v[60:63], v[236:239]
    s_waitcnt lgkmcnt(9)
    ds_read_b128 a[128:131], v0 offset:24576
    v_fma_f32 v75, v75, s23, -v19
    v_mfma_f32_16x16x32_bf16 v[252:255], a[132:135], v[60:63], v[252:255]
    v_add_f32 v26, v26, v36
    v_add_f32 v26, v26, v37
    v_mfma_f32_16x16x32_bf16 v[248:251], a[132:135], v[56:59], v[248:251]
    v_xor_b32 v2, 0xc000, v2
    v_cvt_pk_bf16_f32 v43, v36, v37
    v_mfma_f32_16x16x32_bf16 v[244:247], a[132:135], v[52:55], v[244:247]
    buffer_store_dwordx4 a[216:219], v12, s[16:19], s31 offen offset:3200
    v_exp_f32 v34, v72
    v_mfma_f32_16x16x32_bf16 v[240:243], a[132:135], v[48:51], v[240:243]
    s_waitcnt lgkmcnt(8)
    ds_read_b128 a[132:135], v1 offset:24576
    v_xor_b32 v3, 0xc000, v3
    v_mfma_f32_16x16x32_bf16 a[152:155], a[136:139], v[48:51], a[152:155]
    v_fma_f32 v76, v76, s23, -v19
    v_xor_b32 v4, 0xc000, v4
    v_mfma_f32_16x16x32_bf16 a[156:159], a[136:139], v[52:55], a[156:159]
    v_exp_f32 v35, v73
    v_mfma_f32_16x16x32_bf16 a[160:163], a[136:139], v[56:59], a[160:163]
    v_xor_b32 v5, 0xc000, v5
    v_fma_f32 v77, v77, s23, -v19
    v_mfma_f32_16x16x32_bf16 a[164:167], a[136:139], v[60:63], a[164:167]
    s_waitcnt lgkmcnt(7)
    ds_read_b128 a[136:139], v0 offset:24704
    v_fma_f32 v78, v78, s23, -v19
    v_mfma_f32_16x16x32_bf16 a[180:183], a[140:143], v[60:63], a[180:183]
    v_exp_f32 v36, v74
    v_mfma_f32_16x16x32_bf16 a[176:179], a[140:143], v[56:59], a[176:179]
    v_add_f32 v27, v34, v35
    v_cvt_pk_bf16_f32 v44, v34, v35
    v_mfma_f32_16x16x32_bf16 a[172:175], a[140:143], v[52:55], a[172:175]
    v_exp_f32 v37, v75
    v_fma_f32 v79, v79, s23, -v19
    v_mfma_f32_16x16x32_bf16 a[168:171], a[140:143], v[48:51], a[168:171]
    s_waitcnt lgkmcnt(6)
    ds_read_b128 a[140:143], v1 offset:24704
    v_add_f32 v27, v27, v36
    v_mfma_f32_16x16x32_bf16 a[184:187], a[144:147], v[48:51], a[184:187]
    v_exp_f32 v34, v76
    v_mfma_f32_16x16x32_bf16 a[188:191], a[144:147], v[52:55], a[188:191]
    v_fma_f32 v80, v80, s23, -v20
    v_add_f32 v27, v27, v37
    v_mfma_f32_16x16x32_bf16 a[192:195], a[144:147], v[56:59], a[192:195]
    v_cvt_pk_bf16_f32 v45, v36, v37
    v_fma_f32 v81, v81, s23, -v20
    v_mfma_f32_16x16x32_bf16 a[196:199], a[144:147], v[60:63], a[196:199]
    s_waitcnt lgkmcnt(4)
    ds_read_b128 a[144:147], v0 offset:24832
    v_add_f32 v27, v27, v34
    v_mfma_f32_16x16x32_bf16 a[212:215], a[148:151], v[60:63], a[212:215]
    buffer_store_dwordx4 a[88:91], v12, s[16:19], s31 offen offset:0
    v_fma_f32 v82, v82, s23, -v20
    v_mfma_f32_16x16x32_bf16 a[208:211], a[148:151], v[56:59], a[208:211]
    v_exp_f32 v35, v77
    v_fma_f32 v83, v83, s23, -v20
    v_mfma_f32_16x16x32_bf16 a[204:207], a[148:151], v[52:55], a[204:207]
    v_exp_f32 v36, v78
    v_mfma_f32_16x16x32_bf16 a[200:203], a[148:151], v[48:51], a[200:203]
    s_waitcnt lgkmcnt(4)
    ds_read_b128 a[148:151], v1 offset:24832
    v_add_f32 v27, v27, v35
    v_mfma_f32_16x16x32_bf16 v[96:99], a[128:131], a[0:3], 0
    s_waitcnt lgkmcnt(4)
    v_cvt_pk_bf16_f32 v46, v34, v35
    v_add_f32 v27, v27, v36
    v_mfma_f32_16x16x32_bf16 v[96:99], a[132:135], a[4:7], v[96:99]
    v_exp_f32 v37, v79
    v_mfma_f32_16x16x32_bf16 v[104:107], a[128:131], a[8:11], 0
    v_add_f32 v27, v27, v37
    v_cvt_pk_bf16_f32 v47, v36, v37
    v_mfma_f32_16x16x32_bf16 v[104:107], a[132:135], a[12:15], v[104:107]
    v_exp_f32 v34, v80
    v_mfma_f32_16x16x32_bf16 v[112:115], a[128:131], a[16:19], 0
    v_fma_f32 v84, v84, s23, -v20
    v_fma_f32 v85, v85, s23, -v20
    v_mfma_f32_16x16x32_bf16 v[112:115], a[132:135], a[20:23], v[112:115]
    v_exp_f32 v35, v81
    v_fma_f32 v86, v86, s23, -v20
    v_mfma_f32_16x16x32_bf16 v[120:123], a[128:131], a[24:27], 0
    ds_read_b128 a[128:131], v0 offset:30720
    v_add_f32 v28, v34, v35
    v_mfma_f32_16x16x32_bf16 v[120:123], a[132:135], a[28:31], v[120:123]
    s_waitcnt lgkmcnt(4)
    ds_read_b128 a[132:135], v1 offset:30720
    v_cvt_pk_bf16_f32 v56, v34, v35
    v_mfma_f32_16x16x32_bf16 v[96:99], a[136:139], a[32:35], v[96:99]
    s_waitcnt lgkmcnt(4)
    v_exp_f32 v36, v82
    v_mfma_f32_16x16x32_bf16 v[96:99], a[140:143], a[36:39], v[96:99]
    v_exp_f32 v37, v83
    v_mfma_f32_16x16x32_bf16 v[104:107], a[136:139], a[40:43], v[104:107]
    buffer_store_dwordx4 a[220:223], v12, s[16:19], s31 offen offset:3328
    v_fma_f32 v87, v87, s23, -v20
    v_mfma_f32_16x16x32_bf16 v[104:107], a[140:143], a[44:47], v[104:107]
    v_add_f32 v28, v28, v36
    v_fma_f32 v88, v88, s23, -v21
    v_mfma_f32_16x16x32_bf16 v[112:115], a[136:139], a[48:51], v[112:115]
    v_exp_f32 v34, v84
    v_add_f32 v28, v28, v37
    v_mfma_f32_16x16x32_bf16 v[112:115], a[140:143], a[52:55], v[112:115]
    v_cvt_pk_bf16_f32 v57, v36, v37
    v_fma_f32 v89, v89, s23, -v21
    v_mfma_f32_16x16x32_bf16 v[120:123], a[136:139], a[56:59], v[120:123]
    ds_read_b128 a[136:139], v0 offset:30848
    v_add_f32 v28, v28, v34
    v_mfma_f32_16x16x32_bf16 v[120:123], a[140:143], a[60:63], v[120:123]
    s_waitcnt lgkmcnt(4)
    ds_read_b128 a[140:143], v1 offset:30848
    v_fma_f32 v90, v90, s23, -v21
    v_mfma_f32_16x16x32_bf16 v[96:99], a[144:147], a[96:99], v[96:99]
    s_waitcnt lgkmcnt(4)
    v_exp_f32 v35, v85
    v_mfma_f32_16x16x32_bf16 v[96:99], a[148:151], a[100:103], v[96:99]
    v_exp_f32 v36, v86
    v_mfma_f32_16x16x32_bf16 v[104:107], a[144:147], a[104:107], v[104:107]
    v_add_f32 v28, v28, v35
    v_cvt_pk_bf16_f32 v58, v34, v35
    v_mfma_f32_16x16x32_bf16 v[104:107], a[148:151], a[108:111], v[104:107]
    v_exp_f32 v37, v87
    v_mfma_f32_16x16x32_bf16 v[112:115], a[144:147], a[112:115], v[112:115]
    v_fma_f32 v91, v91, s23, -v21
    v_add_f32 v28, v28, v36
    v_add_f32 v28, v28, v37
    v_mfma_f32_16x16x32_bf16 v[112:115], a[148:151], a[116:119], v[112:115]
    v_cvt_pk_bf16_f32 v59, v36, v37
    v_fma_f32 v92, v92, s23, -v21
    v_mfma_f32_16x16x32_bf16 v[120:123], a[144:147], a[120:123], v[120:123]
    ds_read_b128 a[144:147], v0 offset:30976
    v_fma_f32 v93, v93, s23, -v21
    v_mfma_f32_16x16x32_bf16 v[120:123], a[148:151], a[124:127], v[120:123]
    s_waitcnt lgkmcnt(4)
    ds_read_b128 a[148:151], v1 offset:30976
    v_xor_b32 v0, 0xc000, v0
    v_mfma_f32_16x16x32_bf16 v[100:103], a[128:131], a[0:3], 0
    s_waitcnt lgkmcnt(4)
    buffer_store_dwordx4 a[92:95], v12, s[16:19], s31 offen offset:3072
    v_fma_f32 v94, v94, s23, -v21
    v_mfma_f32_16x16x32_bf16 v[100:103], a[132:135], a[4:7], v[100:103]
    v_exp_f32 v34, v88
    v_mfma_f32_16x16x32_bf16 v[108:111], a[128:131], a[8:11], 0
    v_exp_f32 v35, v89
    v_mfma_f32_16x16x32_bf16 v[108:111], a[132:135], a[12:15], v[108:111]
    v_exp_f32 v36, v90
    v_add_f32 v29, v34, v35
    v_mfma_f32_16x16x32_bf16 v[116:119], a[128:131], a[16:19], 0
    v_xor_b32 v1, 0xc000, v1
    v_cvt_pk_bf16_f32 v60, v34, v35
    v_mfma_f32_16x16x32_bf16 v[116:119], a[132:135], a[20:23], v[116:119]
    s_waitcnt vmcnt(24) lgkmcnt(0)
    v_exp_f32 v37, v91
    v_mfma_f32_16x16x32_bf16 v[124:127], a[128:131], a[24:27], 0
    s_barrier
    ds_read_b64_tr_b16 a[128:129], v2 offset:12288
    ds_read_b64_tr_b16 a[130:131], v2 offset:18432
    v_mfma_f32_16x16x32_bf16 v[124:127], a[132:135], a[28:31], v[124:127]
    s_add_u32 m0, s22, 24576
    ds_read_b64_tr_b16 a[132:133], v3 offset:12288
    ds_read_b64_tr_b16 a[134:135], v3 offset:18432
    v_mfma_f32_16x16x32_bf16 v[100:103], a[136:139], a[32:35], v[100:103]
    buffer_load_dwordx4 v8, s[4:7], s20 offen offset:0 nt lds
    v_fma_f32 v95, v95, s23, -v21
    v_mfma_f32_16x16x32_bf16 v[100:103], a[140:143], a[36:39], v[100:103]
    v_add_f32 v29, v29, v36
    v_add_f32 v29, v29, v37
    v_mfma_f32_16x16x32_bf16 v[108:111], a[136:139], a[40:43], v[108:111]
    v_exp_f32 v34, v92
    v_mfma_f32_16x16x32_bf16 v[108:111], a[140:143], a[44:47], v[108:111]
    v_cvt_pk_bf16_f32 v61, v36, v37
    v_exp_f32 v35, v93
    v_mfma_f32_16x16x32_bf16 v[116:119], a[136:139], a[48:51], v[116:119]
    buffer_load_dwordx4 v9, s[4:7], s20 offen offset:1024 nt lds
    v_add_f32 v29, v29, v34
    v_mfma_f32_16x16x32_bf16 v[116:119], a[140:143], a[52:55], v[116:119]
    v_exp_f32 v36, v94
    v_mfma_f32_16x16x32_bf16 v[124:127], a[136:139], a[56:59], v[124:127]
    ds_read_b64_tr_b16 a[136:137], v4 offset:12288
    ds_read_b64_tr_b16 a[138:139], v4 offset:18432
    v_mfma_f32_16x16x32_bf16 v[124:127], a[140:143], a[60:63], v[124:127]
    ds_read_b64_tr_b16 a[140:141], v5 offset:12288
    ds_read_b64_tr_b16 a[142:143], v5 offset:18432
    v_mfma_f32_16x16x32_bf16 v[100:103], a[144:147], a[96:99], v[100:103]
    buffer_load_dwordx4 v10, s[4:7], s20 offen offset:2048 nt lds
    v_add_f32 v29, v29, v35
    v_mfma_f32_16x16x32_bf16 v[100:103], a[148:151], a[100:103], v[100:103]
    s_add_u32 s20, s20, 12288
    v_cvt_pk_bf16_f32 v62, v34, v35
    v_add_f32 v29, v29, v36
    v_mfma_f32_16x16x32_bf16 v[108:111], a[144:147], a[104:107], v[108:111]
    v_exp_f32 v37, v95
    v_max3_f32 v39, v26, v27, v28
    v_mfma_f32_16x16x32_bf16 v[108:111], a[148:151], a[108:111], v[108:111]
    v_add_f32 v29, v29, v37
    v_cvt_pk_bf16_f32 v63, v36, v37
    v_mfma_f32_16x16x32_bf16 v[116:119], a[144:147], a[112:115], v[116:119]
    v_max_f32 v39, v39, v29
    v_cmp_nge_f32 vcc, 0x44800000, v39
    s_cbranch_vccnz Lrs11
Lrr12:
    v_mfma_f32_16x16x32_bf16 v[116:119], a[148:151], a[116:119], v[116:119]
    s_waitcnt lgkmcnt(6)
    v_add_f32 v22, v22, v26
    v_add_f32 v23, v23, v27
    v_mfma_f32_16x16x32_bf16 v[124:127], a[144:147], a[120:123], v[124:127]
    v_add_f32 v24, v24, v28
    v_add_f32 v25, v25, v29
    v_mfma_f32_16x16x32_bf16 v[124:127], a[148:151], a[124:127], v[124:127]
    s_mov_b32 s25, 0
Lloop2:
    v_mfma_f32_16x16x32_bf16 v[128:131], a[128:131], v[40:43], v[128:131]
    ds_read_b64_tr_b16 a[144:145], v2 offset:12416
    ds_read_b64_tr_b16 a[146:147], v2 offset:18560
    v_mfma_f32_16x16x32_bf16 v[132:135], a[128:131], v[44:47], v[132:135]
    s_add_u32 m0, s22, 36864
    ds_read_b64_tr_b16 a[148:149], v3 offset:12416
    ds_read_b64_tr_b16 a[150:151], v3 offset:18560
    v_mfma_f32_16x16x32_bf16 v[136:139], a[128:131], v[56:59], v[136:139]
    buffer_load_dwordx4 v8, s[8:11], s21 offen offset:0 nt lds
    ds_read_b128 a[216:219], v17 offset:8192
    v_mfma_f32_16x16x32_bf16 v[140:143], a[128:131], v[60:63], v[140:143]
    s_waitcnt lgkmcnt(9)
    ds_read_b64_tr_b16 a[128:129], v4 offset:12416
    ds_read_b64_tr_b16 a[130:131], v4 offset:18560
    v_mfma_f32_16x16x32_bf16 v[156:159], a[132:135], v[60:63], v[156:159]
    v_fma_f32 v96, v96, s23, -v18
    v_fma_f32 v97, v97, s23, -v18
    v_mfma_f32_16x16x32_bf16 v[152:155], a[132:135], v[56:59], v[152:155]
    v_fma_f32 v98, v98, s23, -v18
    v_fma_f32 v99, v99, s23, -v18
    v_mfma_f32_16x16x32_bf16 v[148:151], a[132:135], v[44:47], v[148:151]
    buffer_load_dwordx4 v9, s[8:11], s21 offen offset:1024 nt lds
    v_fma_f32 v100, v100, s23, -v18
    v_mfma_f32_16x16x32_bf16 v[144:147], a[132:135], v[40:43], v[144:147]
    s_waitcnt lgkmcnt(9)
    ds_read_b64_tr_b16 a[132:133], v5 offset:12416
    ds_read_b64_tr_b16 a[134:135], v5 offset:18560
    v_mfma_f32_16x16x32_bf16 v[160:163], a[136:139], v[40:43], v[160:163]
    v_exp_f32 v34, v96
    v_mfma_f32_16x16x32_bf16 v[164:167], a[136:139], v[44:47], v[164:167]
    v_exp_f32 v35, v97
    v_mfma_f32_16x16x32_bf16 v[168:171], a[136:139], v[56:59], v[168:171]
    buffer_load_dwordx4 v10, s[8:11], s21 offen offset:2048 nt lds
    v_fma_f32 v101, v101, s23, -v18
    v_mfma_f32_16x16x32_bf16 v[172:175], a[136:139], v[60:63], v[172:175]
    s_waitcnt lgkmcnt(9)
    ds_read_b64_tr_b16 a[136:137], v2 offset:12544
    ds_read_b64_tr_b16 a[138:139], v2 offset:18688
    v_mfma_f32_16x16x32_bf16 v[188:191], a[140:143], v[60:63], v[188:191]
    s_add_u32 s21, s21, 12288
    v_exp_f32 v36, v98
    v_mfma_f32_16x16x32_bf16 v[184:187], a[140:143], v[56:59], v[184:187]
    v_fma_f32 v102, v102, s23, -v18
    v_add_f32 v26, v34, v35
    v_mfma_f32_16x16x32_bf16 v[180:183], a[140:143], v[44:47], v[180:183]
    s_xor_b32 s22, s22, 0xc000
    v_cvt_pk_bf16_f32 v48, v34, v35
    v_fma_f32 v103, v103, s23, -v18
    v_mfma_f32_16x16x32_bf16 v[176:179], a[140:143], v[40:43], v[176:179]
    s_waitcnt lgkmcnt(9)
    ds_read_b64_tr_b16 a[140:141], v3 offset:12544
    ds_read_b64_tr_b16 a[142:143], v3 offset:18688
    v_mfma_f32_16x16x32_bf16 v[192:195], a[144:147], v[40:43], v[192:195]
    v_exp_f32 v37, v99
    v_mfma_f32_16x16x32_bf16 v[196:199], a[144:147], v[44:47], v[196:199]
    v_add_f32 v26, v26, v36
    v_fma_f32 v104, v104, s23, -v19
    v_mfma_f32_16x16x32_bf16 v[200:203], a[144:147], v[56:59], v[200:203]
    v_exp_f32 v34, v100
    v_mfma_f32_16x16x32_bf16 v[204:207], a[144:147], v[60:63], v[204:207]
    s_waitcnt lgkmcnt(9)
    ds_read_b64_tr_b16 a[144:145], v4 offset:12544
    ds_read_b64_tr_b16 a[146:147], v4 offset:18688
    v_mfma_f32_16x16x32_bf16 v[220:223], a[148:151], v[60:63], v[220:223]
    v_add_f32 v26, v26, v37
    v_cvt_pk_bf16_f32 v49, v36, v37
    v_mfma_f32_16x16x32_bf16 v[216:219], a[148:151], v[56:59], v[216:219]
    v_exp_f32 v35, v101
    v_mfma_f32_16x16x32_bf16 v[212:215], a[148:151], v[44:47], v[212:215]
    v_fma_f32 v105, v105, s23, -v19
    v_add_f32 v26, v26, v34
    v_mfma_f32_16x16x32_bf16 v[208:211], a[148:151], v[40:43], v[208:211]
    s_waitcnt lgkmcnt(8)
    ds_read_b64_tr_b16 a[148:149], v5 offset:12544
    ds_read_b64_tr_b16 a[150:151], v5 offset:18688
    v_mfma_f32_16x16x32_bf16 v[224:227], a[128:131], v[40:43], v[224:227]
    v_exp_f32 v36, v102
    v_mfma_f32_16x16x32_bf16 v[228:231], a[128:131], v[44:47], v[228:231]
    v_fma_f32 v106, v106, s23, -v19
    v_add_f32 v26, v26, v35
    v_mfma_f32_16x16x32_bf16 v[232:235], a[128:131], v[56:59], v[232:235]
    v_cvt_pk_bf16_f32 v50, v34, v35
    v_fma_f32 v107, v107, s23, -v19
    v_mfma_f32_16x16x32_bf16 v[236:239], a[128:131], v[60:63], v[236:239]
    s_waitcnt lgkmcnt(8)
    ds_read_b128 a[128:131], v0 offset:0
    v_add_f32 v26, v26, v36
    v_mfma_f32_16x16x32_bf16 v[252:255], a[132:135], v[60:63], v[252:255]
    v_exp_f32 v37, v103
    v_mfma_f32_16x16x32_bf16 v[248:251], a[132:135], v[56:59], v[248:251]
    v_add_f32 v26, v26, v37
    v_cvt_pk_bf16_f32 v51, v36, v37
    v_mfma_f32_16x16x32_bf16 v[244:247], a[132:135], v[44:47], v[244:247]
    v_exp_f32 v34, v104
    v_mfma_f32_16x16x32_bf16 v[240:243], a[132:135], v[40:43], v[240:243]
    s_waitcnt lgkmcnt(7)
    ds_read_b128 a[132:135], v1 offset:0
    v_fma_f32 v108, v108, s23, -v19
    v_mfma_f32_16x16x32_bf16 a[152:155], a[136:139], v[40:43], a[152:155]
    v_exp_f32 v35, v105
    v_mfma_f32_16x16x32_bf16 a[156:159], a[136:139], v[44:47], a[156:159]
    v_fma_f32 v109, v109, s23, -v19
    v_fma_f32 v110, v110, s23, -v19
    v_mfma_f32_16x16x32_bf16 a[160:163], a[136:139], v[56:59], a[160:163]
    v_exp_f32 v36, v106
    v_mfma_f32_16x16x32_bf16 a[164:167], a[136:139], v[60:63], a[164:167]
    s_waitcnt lgkmcnt(6)
    ds_read_b128 a[136:139], v0 offset:128
    v_add_f32 v27, v34, v35
    v_mfma_f32_16x16x32_bf16 a[180:183], a[140:143], v[60:63], a[180:183]
    v_cvt_pk_bf16_f32 v52, v34, v35
    v_fma_f32 v111, v111, s23, -v19
    v_mfma_f32_16x16x32_bf16 a[176:179], a[140:143], v[56:59], a[176:179]
    v_exp_f32 v37, v107
    v_mfma_f32_16x16x32_bf16 a[172:175], a[140:143], v[44:47], a[172:175]
    v_add_f32 v27, v27, v36
    v_fma_f32 v112, v112, s23, -v20
    v_mfma_f32_16x16x32_bf16 a[168:171], a[140:143], v[40:43], a[168:171]
    s_waitcnt lgkmcnt(5)
    ds_read_b128 a[140:143], v1 offset:128
    v_add_f32 v27, v27, v37
    v_mfma_f32_16x16x32_bf16 a[184:187], a[144:147], v[40:43], a[184:187]
    buffer_store_dwordx4 a[216:219], v12, s[16:19], s27 offen offset:128 sc0 sc1
    v_cvt_pk_bf16_f32 v53, v36, v37
    v_mfma_f32_16x16x32_bf16 a[188:191], a[144:147], v[44:47], a[188:191]
    v_exp_f32 v34, v108
    v_mfma_f32_16x16x32_bf16 a[192:195], a[144:147], v[56:59], a[192:195]
    v_exp_f32 v35, v109
    v_mfma_f32_16x16x32_bf16 a[196:199], a[144:147], v[60:63], a[196:199]
    s_waitcnt lgkmcnt(4)
    ds_read_b128 a[144:147], v0 offset:256
    v_fma_f32 v113, v113, s23, -v20
    v_mfma_f32_16x16x32_bf16 a[212:215], a[148:151], v[60:63], a[212:215]
    v_add_f32 v27, v27, v34
    v_fma_f32 v114, v114, s23, -v20
    v_mfma_f32_16x16x32_bf16 a[208:211], a[148:151], v[56:59], a[208:211]
    v_exp_f32 v36, v110
    v_mfma_f32_16x16x32_bf16 a[204:207], a[148:151], v[44:47], a[204:207]
    v_add_f32 v27, v27, v35
    v_cvt_pk_bf16_f32 v54, v34, v35
    v_mfma_f32_16x16x32_bf16 a[200:203], a[148:151], v[40:43], a[200:203]
    s_waitcnt lgkmcnt(4)
    ds_read_b128 a[148:151], v1 offset:256
    v_fma_f32 v115, v115, s23, -v20
    v_mfma_f32_16x16x32_bf16 v[64:67], a[128:131], a[0:3], 0
    s_waitcnt lgkmcnt(4)
    v_exp_f32 v37, v111
    v_mfma_f32_16x16x32_bf16 v[64:67], a[132:135], a[4:7], v[64:67]
    v_add_f32 v27, v27, v36
    v_add_f32 v27, v27, v37
    v_mfma_f32_16x16x32_bf16 v[72:75], a[128:131], a[8:11], 0
    v_cvt_pk_bf16_f32 v55, v36, v37
    v_fma_f32 v116, v116, s23, -v20
    v_mfma_f32_16x16x32_bf16 v[72:75], a[132:135], a[12:15], v[72:75]
    v_exp_f32 v34, v112
    v_mfma_f32_16x16x32_bf16 v[80:83], a[128:131], a[16:19], 0
    v_exp_f32 v35, v113
    v_mfma_f32_16x16x32_bf16 v[80:83], a[132:135], a[20:23], v[80:83]
    v_fma_f32 v117, v117, s23, -v20
    v_fma_f32 v118, v118, s23, -v20
    v_mfma_f32_16x16x32_bf16 v[88:91], a[128:131], a[24:27], 0
    ds_read_b128 a[128:131], v0 offset:6144
    v_add_f32 v28, v34, v35
    v_mfma_f32_16x16x32_bf16 v[88:91], a[132:135], a[28:31], v[88:91]
    s_waitcnt lgkmcnt(4)
    ds_read_b128 a[132:135], v1 offset:6144
    v_cvt_pk_bf16_f32 v56, v34, v35
    v_mfma_f32_16x16x32_bf16 v[64:67], a[136:139], a[32:35], v[64:67]
    s_waitcnt lgkmcnt(4)
    v_exp_f32 v36, v114
    v_mfma_f32_16x16x32_bf16 v[64:67], a[140:143], a[36:39], v[64:67]
    v_exp_f32 v37, v115
    v_mfma_f32_16x16x32_bf16 v[72:75], a[136:139], a[40:43], v[72:75]
    v_fma_f32 v119, v119, s23, -v20
    v_add_f32 v28, v28, v36
    v_mfma_f32_16x16x32_bf16 v[72:75], a[140:143], a[44:47], v[72:75]
    v_exp_f32 v34, v116
    v_mfma_f32_16x16x32_bf16 v[80:83], a[136:139], a[48:51], v[80:83]
    v_fma_f32 v120, v120, s23, -v21
    v_add_f32 v28, v28, v37
    v_cvt_pk_bf16_f32 v57, v36, v37
    v_mfma_f32_16x16x32_bf16 v[80:83], a[140:143], a[52:55], v[80:83]
    v_exp_f32 v35, v117
    v_mfma_f32_16x16x32_bf16 v[88:91], a[136:139], a[56:59], v[88:91]
    ds_read_b128 a[136:139], v0 offset:6272
    v_fma_f32 v121, v121, s23, -v21
    v_mfma_f32_16x16x32_bf16 v[88:91], a[140:143], a[60:63], v[88:91]
    s_waitcnt lgkmcnt(4)
    ds_read_b128 a[140:143], v1 offset:6272
    v_add_f32 v28, v28, v34
    v_mfma_f32_16x16x32_bf16 v[64:67], a[144:147], a[96:99], v[64:67]
    s_waitcnt lgkmcnt(4)
    v_exp_f32 v36, v118
    v_mfma_f32_16x16x32_bf16 v[64:67], a[148:151], a[100:103], v[64:67]
    v_fma_f32 v122, v122, s23, -v21
    v_add_f32 v28, v28, v35
    v_mfma_f32_16x16x32_bf16 v[72:75], a[144:147], a[104:107], v[72:75]
    v_cvt_pk_bf16_f32 v58, v34, v35
    v_fma_f32 v123, v123, s23, -v21
    v_mfma_f32_16x16x32_bf16 v[72:75], a[148:151], a[108:111], v[72:75]
    v_exp_f32 v37, v119
    v_mfma_f32_16x16x32_bf16 v[80:83], a[144:147], a[112:115], v[80:83]
    v_add_f32 v28, v28, v36
    v_add_f32 v28, v28, v37
    v_mfma_f32_16x16x32_bf16 v[80:83], a[148:151], a[116:119], v[80:83]
    v_cvt_pk_bf16_f32 v59, v36, v37
    v_fma_f32 v124, v124, s23, -v21
    v_mfma_f32_16x16x32_bf16 v[88:91], a[144:147], a[120:123], v[88:91]
    ds_read_b128 a[144:147], v0 offset:6400
    v_fma_f32 v125, v125, s23, -v21
    v_mfma_f32_16x16x32_bf16 v[88:91], a[148:151], a[124:127], v[88:91]
    s_waitcnt lgkmcnt(4)
    ds_read_b128 a[148:151], v1 offset:6400
    v_fma_f32 v126, v126, s23, -v21
    v_mfma_f32_16x16x32_bf16 v[68:71], a[128:131], a[0:3], 0
    s_waitcnt lgkmcnt(4)
    v_exp_f32 v34, v120
    v_mfma_f32_16x16x32_bf16 v[68:71], a[132:135], a[4:7], v[68:71]
    v_exp_f32 v35, v121
    v_mfma_f32_16x16x32_bf16 v[76:79], a[128:131], a[8:11], 0
    v_exp_f32 v36, v122
    v_mfma_f32_16x16x32_bf16 v[76:79], a[132:135], a[12:15], v[76:79]
    v_add_f32 v29, v34, v35
    v_cvt_pk_bf16_f32 v60, v34, v35
    v_mfma_f32_16x16x32_bf16 v[84:87], a[128:131], a[16:19], 0
    v_exp_f32 v37, v123
    v_mfma_f32_16x16x32_bf16 v[84:87], a[132:135], a[20:23], v[84:87]
    s_waitcnt vmcnt(16) lgkmcnt(0)
    v_fma_f32 v127, v127, s23, -v21
    v_add_f32 v29, v29, v36
    v_mfma_f32_16x16x32_bf16 v[92:95], a[128:131], a[24:27], 0
    s_barrier
    ds_read_b64_tr_b16 a[128:129], v2 offset:36864
    ds_read_b64_tr_b16 a[130:131], v2 offset:43008
    v_mfma_f32_16x16x32_bf16 v[92:95], a[132:135], a[28:31], v[92:95]
    s_add_u32 m0, s22, 0
    ds_read_b64_tr_b16 a[132:133], v3 offset:36864
    ds_read_b64_tr_b16 a[134:135], v3 offset:43008
    v_mfma_f32_16x16x32_bf16 v[68:71], a[136:139], a[32:35], v[68:71]
    buffer_load_dwordx4 v8, s[4:7], s20 offen offset:0 nt lds
    v_add_f32 v29, v29, v37
    v_mfma_f32_16x16x32_bf16 v[68:71], a[140:143], a[36:39], v[68:71]
    v_exp_f32 v34, v124
    v_mfma_f32_16x16x32_bf16 v[76:79], a[136:139], a[40:43], v[76:79]
    v_cvt_pk_bf16_f32 v61, v36, v37
    v_add_f32 v29, v29, v34
    v_mfma_f32_16x16x32_bf16 v[76:79], a[140:143], a[44:47], v[76:79]
    v_exp_f32 v35, v125
    v_mfma_f32_16x16x32_bf16 v[84:87], a[136:139], a[48:51], v[84:87]
    buffer_load_dwordx4 v9, s[4:7], s20 offen offset:1024 nt lds
    v_add_f32 v29, v29, v35
    v_mfma_f32_16x16x32_bf16 v[84:87], a[140:143], a[52:55], v[84:87]
    v_exp_f32 v36, v126
    v_mfma_f32_16x16x32_bf16 v[92:95], a[136:139], a[56:59], v[92:95]
    ds_read_b64_tr_b16 a[136:137], v4 offset:36864
    ds_read_b64_tr_b16 a[138:139], v4 offset:43008
    v_mfma_f32_16x16x32_bf16 v[92:95], a[140:143], a[60:63], v[92:95]
    ds_read_b64_tr_b16 a[140:141], v5 offset:36864
    ds_read_b64_tr_b16 a[142:143], v5 offset:43008
    v_mfma_f32_16x16x32_bf16 v[68:71], a[144:147], a[96:99], v[68:71]
    buffer_load_dwordx4 v10, s[4:7], s20 offen offset:2048 nt lds
    v_cvt_pk_bf16_f32 v62, v34, v35
    v_mfma_f32_16x16x32_bf16 v[68:71], a[148:151], a[100:103], v[68:71]
    s_add_u32 s20, s20, 12288
    v_exp_f32 v37, v127
    v_mfma_f32_16x16x32_bf16 v[76:79], a[144:147], a[104:107], v[76:79]
    v_add_f32 v29, v29, v36
    v_add_f32 v29, v29, v37
    v_mfma_f32_16x16x32_bf16 v[76:79], a[148:151], a[108:111], v[76:79]
    v_cvt_pk_bf16_f32 v63, v36, v37
    v_max3_f32 v39, v26, v27, v28
    v_mfma_f32_16x16x32_bf16 v[84:87], a[144:147], a[112:115], v[84:87]
    v_max_f32 v39, v39, v29
    v_cmp_nge_f32 vcc, 0x44800000, v39
    s_cbranch_vccnz Lrs13
Lrr14:
    v_mfma_f32_16x16x32_bf16 v[84:87], a[148:151], a[116:119], v[84:87]
    s_waitcnt lgkmcnt(6)
    v_add_f32 v22, v22, v26
    v_add_f32 v23, v23, v27
    v_mfma_f32_16x16x32_bf16 v[92:95], a[144:147], a[120:123], v[92:95]
    v_add_f32 v24, v24, v28
    v_add_f32 v25, v25, v29
    v_mfma_f32_16x16x32_bf16 v[92:95], a[148:151], a[124:127], v[92:95]
    v_mfma_f32_16x16x32_bf16 v[128:131], a[128:131], v[48:51], v[128:131]
    ds_read_b64_tr_b16 a[144:145], v2 offset:36992
    ds_read_b64_tr_b16 a[146:147], v2 offset:43136
    v_mfma_f32_16x16x32_bf16 v[132:135], a[128:131], v[52:55], v[132:135]
    s_add_u32 m0, s22, 12288
    ds_read_b64_tr_b16 a[148:149], v3 offset:36992
    ds_read_b64_tr_b16 a[150:151], v3 offset:43136
    v_mfma_f32_16x16x32_bf16 v[136:139], a[128:131], v[56:59], v[136:139]
    buffer_load_dwordx4 v8, s[8:11], s21 offen offset:0 nt lds
    ds_read_b128 a[220:223], v17 offset:0
    v_mfma_f32_16x16x32_bf16 v[140:143], a[128:131], v[60:63], v[140:143]
    s_waitcnt lgkmcnt(9)
    ds_read_b64_tr_b16 a[128:129], v4 offset:36992
    ds_read_b64_tr_b16 a[130:131], v4 offset:43136
    v_mfma_f32_16x16x32_bf16 v[156:159], a[132:135], v[60:63], v[156:159]
    v_fma_f32 v64, v64, s23, -v18
    v_fma_f32 v65, v65, s23, -v18
    v_mfma_f32_16x16x32_bf16 v[152:155], a[132:135], v[56:59], v[152:155]
    v_fma_f32 v66, v66, s23, -v18
    v_fma_f32 v67, v67, s23, -v18
    v_mfma_f32_16x16x32_bf16 v[148:151], a[132:135], v[52:55], v[148:151]
    buffer_load_dwordx4 v9, s[8:11], s21 offen offset:1024 nt lds
    v_fma_f32 v68, v68, s23, -v18
    v_mfma_f32_16x16x32_bf16 v[144:147], a[132:135], v[48:51], v[144:147]
    s_waitcnt lgkmcnt(9)
    ds_read_b64_tr_b16 a[132:133], v5 offset:36992
    ds_read_b64_tr_b16 a[134:135], v5 offset:43136
    v_mfma_f32_16x16x32_bf16 v[160:163], a[136:139], v[48:51], v[160:163]
    v_exp_f32 v34, v64
    v_mfma_f32_16x16x32_bf16 v[164:167], a[136:139], v[52:55], v[164:167]
    v_exp_f32 v35, v65
    v_mfma_f32_16x16x32_bf16 v[168:171], a[136:139], v[56:59], v[168:171]
    buffer_load_dwordx4 v10, s[8:11], s21 offen offset:2048 nt lds
    v_fma_f32 v69, v69, s23, -v18
    v_fma_f32 v70, v70, s23, -v18
    v_mfma_f32_16x16x32_bf16 v[172:175], a[136:139], v[60:63], v[172:175]
    s_waitcnt lgkmcnt(9)
    ds_read_b64_tr_b16 a[136:137], v2 offset:37120
    ds_read_b64_tr_b16 a[138:139], v2 offset:43264
    v_mfma_f32_16x16x32_bf16 v[188:191], a[140:143], v[60:63], v[188:191]
    s_add_u32 s21, s21, 12288
    v_exp_f32 v36, v66
    v_mfma_f32_16x16x32_bf16 v[184:187], a[140:143], v[56:59], v[184:187]
    v_add_f32 v26, v34, v35
    v_cvt_pk_bf16_f32 v40, v34, v35
    v_mfma_f32_16x16x32_bf16 v[180:183], a[140:143], v[52:55], v[180:183]
    v_exp_f32 v37, v67
    v_mfma_f32_16x16x32_bf16 v[176:179], a[140:143], v[48:51], v[176:179]
    s_waitcnt lgkmcnt(9)
    ds_read_b64_tr_b16 a[140:141], v3 offset:37120
    ds_read_b64_tr_b16 a[142:143], v3 offset:43264
    v_mfma_f32_16x16x32_bf16 v[192:195], a[144:147], v[48:51], v[192:195]
    v_fma_f32 v71, v71, s23, -v18
    v_add_f32 v26, v26, v36
    v_mfma_f32_16x16x32_bf16 v[196:199], a[144:147], v[52:55], v[196:199]
    v_exp_f32 v34, v68
    v_mfma_f32_16x16x32_bf16 v[200:203], a[144:147], v[56:59], v[200:203]
    v_fma_f32 v72, v72, s23, -v19
    v_add_f32 v26, v26, v37
    v_mfma_f32_16x16x32_bf16 v[204:207], a[144:147], v[60:63], v[204:207]
    s_waitcnt lgkmcnt(9)
    ds_read_b64_tr_b16 a[144:145], v4 offset:37120
    ds_read_b64_tr_b16 a[146:147], v4 offset:43264
    v_cvt_pk_bf16_f32 v41, v36, v37
    v_mfma_f32_16x16x32_bf16 v[220:223], a[148:151], v[60:63], v[220:223]
    v_exp_f32 v35, v69
    v_mfma_f32_16x16x32_bf16 v[216:219], a[148:151], v[56:59], v[216:219]
    v_fma_f32 v73, v73, s23, -v19
    v_add_f32 v26, v26, v34
    v_mfma_f32_16x16x32_bf16 v[212:215], a[148:151], v[52:55], v[212:215]
    v_exp_f32 v36, v70
    v_mfma_f32_16x16x32_bf16 v[208:211], a[148:151], v[48:51], v[208:211]
    s_waitcnt lgkmcnt(8)
    ds_read_b64_tr_b16 a[148:149], v5 offset:37120
    ds_read_b64_tr_b16 a[150:151], v5 offset:43264
    v_mfma_f32_16x16x32_bf16 v[224:227], a[128:131], v[48:51], v[224:227]
    v_fma_f32 v74, v74, s23, -v19
    v_add_f32 v26, v26, v35
    v_mfma_f32_16x16x32_bf16 v[228:231], a[128:131], v[52:55], v[228:231]
    v_cvt_pk_bf16_f32 v42, v34, v35
    v_fma_f32 v75, v75, s23, -v19
    v_mfma_f32_16x16x32_bf16 v[232:235], a[128:131], v[56:59], v[232:235]
    v_exp_f32 v37, v71
    v_mfma_f32_16x16x32_bf16 v[236:239], a[128:131], v[60:63], v[236:239]
    s_waitcnt lgkmcnt(8)
    ds_read_b128 a[128:131], v0 offset:24576
    v_add_f32 v26, v26, v36
    v_mfma_f32_16x16x32_bf16 v[252:255], a[132:135], v[60:63], v[252:255]
    v_add_u32 v17, 1024, v17
    v_add_f32 v26, v26, v37
    v_mfma_f32_16x16x32_bf16 v[248:251], a[132:135], v[56:59], v[248:251]
    v_xor_b32 v2, 0xc000, v2
    v_cvt_pk_bf16_f32 v43, v36, v37
    v_mfma_f32_16x16x32_bf16 v[244:247], a[132:135], v[52:55], v[244:247]
    v_exp_f32 v34, v72
    v_xor_b32 v3, 0xc000, v3
    v_mfma_f32_16x16x32_bf16 v[240:243], a[132:135], v[48:51], v[240:243]
    s_waitcnt lgkmcnt(7)
    ds_read_b128 a[132:135], v1 offset:24576
    v_fma_f32 v76, v76, s23, -v19
    v_mfma_f32_16x16x32_bf16 a[152:155], a[136:139], v[48:51], a[152:155]
    v_xor_b32 v4, 0xc000, v4
    v_xor_b32 v5, 0xc000, v5
    v_mfma_f32_16x16x32_bf16 a[156:159], a[136:139], v[52:55], a[156:159]
    v_exp_f32 v35, v73
    v_mfma_f32_16x16x32_bf16 a[160:163], a[136:139], v[56:59], a[160:163]
    v_fma_f32 v77, v77, s23, -v19
    v_fma_f32 v78, v78, s23, -v19
    v_mfma_f32_16x16x32_bf16 a[164:167], a[136:139], v[60:63], a[164:167]
    s_waitcnt lgkmcnt(6)
    ds_read_b128 a[136:139], v0 offset:24704
    v_add_f32 v27, v34, v35
    v_mfma_f32_16x16x32_bf16 a[180:183], a[140:143], v[60:63], a[180:183]
    v_exp_f32 v36, v74
    v_mfma_f32_16x16x32_bf16 a[176:179], a[140:143], v[56:59], a[176:179]
    v_cvt_pk_bf16_f32 v44, v34, v35
    v_fma_f32 v79, v79, s23, -v19
    v_mfma_f32_16x16x32_bf16 a[172:175], a[140:143], v[52:55], a[172:175]
    v_exp_f32 v37, v75
    v_mfma_f32_16x16x32_bf16 a[168:171], a[140:143], v[48:51], a[168:171]
    s_waitcnt lgkmcnt(5)
    ds_read_b128 a[140:143], v1 offset:24704
    v_add_f32 v27, v27, v36
    v_fma_f32 v80, v80, s23, -v20
    v_mfma_f32_16x16x32_bf16 a[184:187], a[144:147], v[48:51], a[184:187]
    buffer_store_dwordx4 a[220:223], v12, s[16:19], s27 offen offset:256 sc0 sc1
    v_add_f32 v27, v27, v37
    v_mfma_f32_16x16x32_bf16 a[188:191], a[144:147], v[52:55], a[188:191]
    v_exp_f32 v34, v76
    v_mfma_f32_16x16x32_bf16 a[192:195], a[144:147], v[56:59], a[192:195]
    s_add_u32 s27, s27, 3072
    v_cvt_pk_bf16_f32 v45, v36, v37
    v_fma_f32 v81, v81, s23, -v20
    v_mfma_f32_16x16x32_bf16 a[196:199], a[144:147], v[60:63], a[196:199]
    s_waitcnt lgkmcnt(4)
    ds_read_b128 a[144:147], v0 offset:24832
    v_add_f32 v27, v27, v34
    v_mfma_f32_16x16x32_bf16 a[212:215], a[148:151], v[60:63], a[212:215]
    v_exp_f32 v35, v77
    v_mfma_f32_16x16x32_bf16 a[208:211], a[148:151], v[56:59], a[208:211]
    v_exp_f32 v36, v78
    v_mfma_f32_16x16x32_bf16 a[204:207], a[148:151], v[52:55], a[204:207]
    v_fma_f32 v82, v82, s23, -v20
    v_add_f32 v27, v27, v35
    v_mfma_f32_16x16x32_bf16 a[200:203], a[148:151], v[48:51], a[200:203]
    s_waitcnt lgkmcnt(4)
    ds_read_b128 a[148:151], v1 offset:24832
    v_cvt_pk_bf16_f32 v46, v34, v35
    v_mfma_f32_16x16x32_bf16 v[96:99], a[128:131], a[0:3], 0
    s_waitcnt lgkmcnt(4)
    v_exp_f32 v37, v79
    v_mfma_f32_16x16x32_bf16 v[96:99], a[132:135], a[4:7], v[96:99]
    v_fma_f32 v83, v83, s23, -v20
    v_add_f32 v27, v27, v36
    v_mfma_f32_16x16x32_bf16 v[104:107], a[128:131], a[8:11], 0
    global_load_dwordx4 a[228:231], v[6:7], off
    v_add_f32 v27, v27, v37
    v_cvt_pk_bf16_f32 v47, v36, v37
    v_mfma_f32_16x16x32_bf16 v[104:107], a[132:135], a[12:15], v[104:107]
    v_exp_f32 v34, v80
    v_mfma_f32_16x16x32_bf16 v[112:115], a[128:131], a[16:19], 0
    v_fma_f32 v84, v84, s23, -v20
    v_fma_f32 v85, v85, s23, -v20
    v_mfma_f32_16x16x32_bf16 v[112:115], a[132:135], a[20:23], v[112:115]
    v_exp_f32 v35, v81
    v_mfma_f32_16x16x32_bf16 v[120:123], a[128:131], a[24:27], 0
    ds_read_b128 a[128:131], v0 offset:30720
    v_fma_f32 v86, v86, s23, -v20
    v_mfma_f32_16x16x32_bf16 v[120:123], a[132:135], a[28:31], v[120:123]
    s_waitcnt lgkmcnt(4)
    ds_read_b128 a[132:135], v1 offset:30720
    v_add_f32 v28, v34, v35
    v_mfma_f32_16x16x32_bf16 v[96:99], a[136:139], a[32:35], v[96:99]
    s_waitcnt lgkmcnt(4)
    v_exp_f32 v36, v82
    v_mfma_f32_16x16x32_bf16 v[96:99], a[140:143], a[36:39], v[96:99]
    v_cvt_pk_bf16_f32 v56, v34, v35
    v_fma_f32 v87, v87, s23, -v20
    v_mfma_f32_16x16x32_bf16 v[104:107], a[136:139], a[40:43], v[104:107]
    v_exp_f32 v37, v83
    v_mfma_f32_16x16x32_bf16 v[104:107], a[140:143], a[44:47], v[104:107]
    v_add_f32 v28, v28, v36
    v_exp_f32 v34, v84
    v_mfma_f32_16x16x32_bf16 v[112:115], a[136:139], a[48:51], v[112:115]
    v_fma_f32 v88, v88, s23, -v21
    v_add_f32 v28, v28, v37
    v_mfma_f32_16x16x32_bf16 v[112:115], a[140:143], a[52:55], v[112:115]
    v_cvt_pk_bf16_f32 v57, v36, v37
    v_fma_f32 v89, v89, s23, -v21
    v_mfma_f32_16x16x32_bf16 v[120:123], a[136:139], a[56:59], v[120:123]
    ds_read_b128 a[136:139], v0 offset:30848
    v_add_f32 v28, v28, v34
    v_mfma_f32_16x16x32_bf16 v[120:123], a[140:143], a[60:63], v[120:123]
    s_waitcnt lgkmcnt(4)
    ds_read_b128 a[140:143], v1 offset:30848
    v_fma_f32 v90, v90, s23, -v21
    v_mfma_f32_16x16x32_bf16 v[96:99], a[144:147], a[96:99], v[96:99]
    s_waitcnt lgkmcnt(4)
    v_exp_f32 v35, v85
    v_mfma_f32_16x16x32_bf16 v[96:99], a[148:151], a[100:103], v[96:99]
    v_exp_f32 v36, v86
    v_mfma_f32_16x16x32_bf16 v[104:107], a[144:147], a[104:107], v[104:107]
    v_add_f32 v28, v28, v35
    v_cvt_pk_bf16_f32 v58, v34, v35
    v_mfma_f32_16x16x32_bf16 v[104:107], a[148:151], a[108:111], v[104:107]
    v_exp_f32 v37, v87
    v_mfma_f32_16x16x32_bf16 v[112:115], a[144:147], a[112:115], v[112:115]
    v_fma_f32 v91, v91, s23, -v21
    v_add_f32 v28, v28, v36
    v_mfma_f32_16x16x32_bf16 v[112:115], a[148:151], a[116:119], v[112:115]
    v_add_f32 v28, v28, v37
    v_cvt_pk_bf16_f32 v59, v36, v37
    v_fma_f32 v92, v92, s23, -v21
    v_mfma_f32_16x16x32_bf16 v[120:123], a[144:147], a[120:123], v[120:123]
    ds_read_b128 a[144:147], v0 offset:30976
    v_fma_f32 v93, v93, s23, -v21
    v_mfma_f32_16x16x32_bf16 v[120:123], a[148:151], a[124:127], v[120:123]
    s_waitcnt lgkmcnt(4)
    ds_read_b128 a[148:151], v1 offset:30976
    v_xor_b32 v0, 0xc000, v0
    v_mfma_f32_16x16x32_bf16 v[100:103], a[128:131], a[0:3], 0
    s_waitcnt lgkmcnt(4)
    v_exp_f32 v34, v88
    v_mfma_f32_16x16x32_bf16 v[100:103], a[132:135], a[4:7], v[100:103]
    v_exp_f32 v35, v89
    v_mfma_f32_16x16x32_bf16 v[108:111], a[128:131], a[8:11], 0
    s_add_u32 s25, s25, 1
    v_exp_f32 v36, v90
    v_mfma_f32_16x16x32_bf16 v[108:111], a[132:135], a[12:15], v[108:111]
    v_fma_f32 v94, v94, s23, -v21
    v_add_f32 v29, v34, v35
    v_mfma_f32_16x16x32_bf16 v[116:119], a[128:131], a[16:19], 0
    v_xor_b32 v1, 0xc000, v1
    v_cvt_pk_bf16_f32 v60, v34, v35
    v_mfma_f32_16x16x32_bf16 v[116:119], a[132:135], a[20:23], v[116:119]
    s_waitcnt vmcnt(17) lgkmcnt(0)
    v_exp_f32 v37, v91
    v_mfma_f32_16x16x32_bf16 v[124:127], a[128:131], a[24:27], 0
    s_barrier
    ds_read_b64_tr_b16 a[128:129], v2 offset:12288
    ds_read_b64_tr_b16 a[130:131], v2 offset:18432
    v_mfma_f32_16x16x32_bf16 v[124:127], a[132:135], a[28:31], v[124:127]
    s_add_u32 m0, s22, 24576
    ds_read_b64_tr_b16 a[132:133], v3 offset:12288
    ds_read_b64_tr_b16 a[134:135], v3 offset:18432
    v_fma_f32 v95, v95, s23, -v21
    v_mfma_f32_16x16x32_bf16 v[100:103], a[136:139], a[32:35], v[100:103]
    buffer_load_dwordx4 v8, s[4:7], s20 offen offset:0 nt lds
    v_add_f32 v29, v29, v36
    v_mfma_f32_16x16x32_bf16 v[100:103], a[140:143], a[36:39], v[100:103]
    v_exp_f32 v34, v92
    v_mfma_f32_16x16x32_bf16 v[108:111], a[136:139], a[40:43], v[108:111]
    v_add_f32 v29, v29, v37
    v_cvt_pk_bf16_f32 v61, v36, v37
    v_mfma_f32_16x16x32_bf16 v[108:111], a[140:143], a[44:47], v[108:111]
    v_exp_f32 v35, v93
    v_mfma_f32_16x16x32_bf16 v[116:119], a[136:139], a[48:51], v[116:119]
    buffer_load_dwordx4 v9, s[4:7], s20 offen offset:1024 nt lds
    v_add_f32 v29, v29, v34
    v_mfma_f32_16x16x32_bf16 v[116:119], a[140:143], a[52:55], v[116:119]
    v_exp_f32 v36, v94
    v_mfma_f32_16x16x32_bf16 v[124:127], a[136:139], a[56:59], v[124:127]
    ds_read_b64_tr_b16 a[136:137], v4 offset:12288
    ds_read_b64_tr_b16 a[138:139], v4 offset:18432
    v_mfma_f32_16x16x32_bf16 v[124:127], a[140:143], a[60:63], v[124:127]
    ds_read_b64_tr_b16 a[140:141], v5 offset:12288
    ds_read_b64_tr_b16 a[142:143], v5 offset:18432
    v_mfma_f32_16x16x32_bf16 v[100:103], a[144:147], a[96:99], v[100:103]
    buffer_load_dwordx4 v10, s[4:7], s20 offen offset:2048 nt lds
    v_add_f32 v29, v29, v35
    v_mfma_f32_16x16x32_bf16 v[100:103], a[148:151], a[100:103], v[100:103]
    s_add_u32 s20, s20, 12288
    v_cvt_pk_bf16_f32 v62, v34, v35
    v_exp_f32 v37, v95
    v_mfma_f32_16x16x32_bf16 v[108:111], a[144:147], a[104:107], v[108:111]
    v_add_f32 v29, v29, v36
    v_add_f32 v29, v29, v37
    v_mfma_f32_16x16x32_bf16 v[108:111], a[148:151], a[108:111], v[108:111]
    v_cvt_pk_bf16_f32 v63, v36, v37
    v_max3_f32 v39, v26, v27, v28
    v_mfma_f32_16x16x32_bf16 v[116:119], a[144:147], a[112:115], v[116:119]
    v_max_f32 v39, v39, v29
    v_cmp_nge_f32 vcc, 0x44800000, v39
    s_cbranch_vccnz Lrs15
Lrr16:
    v_mfma_f32_16x16x32_bf16 v[116:119], a[148:151], a[116:119], v[116:119]
    s_waitcnt lgkmcnt(6)
    v_add_f32 v22, v22, v26
    v_add_f32 v23, v23, v27
    v_mfma_f32_16x16x32_bf16 v[124:127], a[144:147], a[120:123], v[124:127]
    s_cmp_lt_u32 s25, 6
    v_add_f32 v24, v24, v28
    v_add_f32 v25, v25, v29
    v_mfma_f32_16x16x32_bf16 v[124:127], a[148:151], a[124:127], v[124:127]
    s_cbranch_scc1 Lloop2
    s_add_u32 s16, s16, 190464
    s_addc_u32 s17, s17, 0
    v_mfma_f32_16x16x32_bf16 v[128:131], a[128:131], v[40:43], v[128:131]
    s_waitcnt lgkmcnt(4)
    ds_read_b64_tr_b16 a[144:145], v2 offset:12416
    ds_read_b64_tr_b16 a[146:147], v2 offset:18560
    ds_read_b64_tr_b16 a[148:149], v3 offset:12416
    ds_read_b64_tr_b16 a[150:151], v3 offset:18560
    ds_read_b64_tr_b16 a[128:129], v4 offset:12416
    ds_read_b64_tr_b16 a[130:131], v4 offset:18560
    v_subrev_u32 v17, 6144, v17
    v_fma_f32 v96, v96, s23, -v18
    v_mfma_f32_16x16x32_bf16 v[144:147], a[132:135], v[40:43], v[144:147]
    s_waitcnt lgkmcnt(8)
    ds_read_b64_tr_b16 a[132:133], v5 offset:12416
    ds_read_b64_tr_b16 a[134:135], v5 offset:18560
    v_fma_f32 v97, v97, s23, -v18
    v_fma_f32 v98, v98, s23, -v18
    v_fma_f32 v99, v99, s23, -v18
    v_exp_f32 v34, v96
    v_fma_f32 v100, v100, s23, -v18
    v_mfma_f32_16x16x32_bf16 v[160:163], a[136:139], v[40:43], v[160:163]
    s_waitcnt lgkmcnt(8)
    ds_read_b64_tr_b16 a[136:137], v2 offset:12544
    ds_read_b64_tr_b16 a[138:139], v2 offset:18688
    v_exp_f32 v35, v97
    v_fma_f32 v101, v101, s23, -v18
    v_exp_f32 v36, v98
    v_fma_f32 v102, v102, s23, -v18
    v_mfma_f32_16x16x32_bf16 v[176:179], a[140:143], v[40:43], v[176:179]
    s_waitcnt lgkmcnt(8)
    ds_read_b64_tr_b16 a[140:141], v3 offset:12544
    ds_read_b64_tr_b16 a[142:143], v3 offset:18688
    v_add_f32 v26, v34, v35
    v_cvt_pk_bf16_f32 v48, v34, v35
    v_exp_f32 v37, v99
    v_fma_f32 v103, v103, s23, -v18
    v_add_f32 v26, v26, v36
    v_add_f32 v26, v26, v37
    v_mfma_f32_16x16x32_bf16 v[192:195], a[144:147], v[40:43], v[192:195]
    s_waitcnt lgkmcnt(8)
    ds_read_b64_tr_b16 a[144:145], v4 offset:12544
    ds_read_b64_tr_b16 a[146:147], v4 offset:18688
    v_exp_f32 v34, v100
    v_cvt_pk_bf16_f32 v49, v36, v37
    v_exp_f32 v35, v101
    v_add_f32 v26, v26, v34
    v_mfma_f32_16x16x32_bf16 v[208:211], a[148:151], v[40:43], v[208:211]
    s_waitcnt lgkmcnt(8)
    ds_read_b64_tr_b16 a[148:149], v5 offset:12544
    ds_read_b64_tr_b16 a[150:151], v5 offset:18688
    v_exp_f32 v36, v102
    v_add_f32 v26, v26, v35
    v_cvt_pk_bf16_f32 v50, v34, v35
    v_exp_f32 v37, v103
    v_mfma_f32_16x16x32_bf16 v[224:227], a[128:131], v[40:43], v[224:227]
    s_waitcnt lgkmcnt(8)
    v_add_f32 v26, v26, v36
    v_add_f32 v26, v26, v37
    v_cvt_pk_bf16_f32 v51, v36, v37
    v_cmp_nge_f32 vcc, 0x44800000, v26
    v_xor_b32 v38, 32, v16
    v_fma_f32 v104, v104, s23, -v19
    v_fma_f32 v105, v105, s23, -v19
    v_fma_f32 v106, v106, s23, -v19
    v_mfma_f32_16x16x32_bf16 v[240:243], a[132:135], v[40:43], v[240:243]
    s_waitcnt lgkmcnt(6)
    v_fma_f32 v107, v107, s23, -v19
    v_exp_f32 v34, v104
    v_fma_f32 v108, v108, s23, -v19
    v_exp_f32 v35, v105
    v_fma_f32 v109, v109, s23, -v19
    v_exp_f32 v36, v106
    v_mfma_f32_16x16x32_bf16 a[152:155], a[136:139], v[40:43], a[152:155]
    s_waitcnt lgkmcnt(4)
    v_fma_f32 v110, v110, s23, -v19
    v_add_f32 v27, v34, v35
    v_cvt_pk_bf16_f32 v52, v34, v35
    v_exp_f32 v37, v107
    v_fma_f32 v111, v111, s23, -v19
    v_add_f32 v27, v27, v36
    v_add_f32 v27, v27, v37
    s_waitcnt vmcnt(12)
    v_mfma_f32_16x16x32_bf16 a[168:171], a[140:143], v[40:43], a[168:171]
    s_waitcnt lgkmcnt(2)
    v_exp_f32 v34, v108
    v_cvt_pk_bf16_f32 v53, v36, v37
    v_exp_f32 v35, v109
    v_add_f32 v27, v27, v34
    v_exp_f32 v36, v110
    s_barrier
    v_mfma_f32_16x16x32_bf16 a[184:187], a[144:147], v[40:43], a[184:187]
    s_waitcnt lgkmcnt(0)
    ds_read_b64_tr_b16 a[128:129], v2 offset:36864
    ds_read_b64_tr_b16 a[130:131], v2 offset:43008
    ds_read_b64_tr_b16 a[132:133], v3 offset:36864
    ds_read_b64_tr_b16 a[134:135], v3 offset:43008
    ds_read_b64_tr_b16 a[136:137], v4 offset:36864
    ds_read_b64_tr_b16 a[138:139], v4 offset:43008
    ds_read_b64_tr_b16 a[140:141], v5 offset:36864
    ds_read_b64_tr_b16 a[142:143], v5 offset:43008
    ds_read_b64_tr_b16 a[144:145], v2 offset:36992
    v_mfma_f32_16x16x32_bf16 a[200:203], a[148:151], v[40:43], a[200:203]
    s_waitcnt lgkmcnt(7)
    ds_read_b64_tr_b16 a[146:147], v2 offset:43136
    ds_read_b64_tr_b16 a[148:149], v3 offset:36992
    ds_read_b64_tr_b16 a[150:151], v3 offset:43136
    v_add_f32 v27, v27, v35
    v_cvt_pk_bf16_f32 v54, v34, v35
    v_exp_f32 v37, v111
    v_add_f32 v27, v27, v36
    s_cbranch_vccnz Lrs17
Lrr18:
    v_mfma_f32_16x16x32_bf16 v[128:131], a[128:131], v[48:51], v[128:131]
    s_waitcnt lgkmcnt(8)
    ds_read_b64_tr_b16 a[128:129], v4 offset:36992
    ds_read_b64_tr_b16 a[130:131], v4 offset:43136
    v_add_f32 v22, v22, v26
    v_mov_b32 v26, v22
    v_mov_b32 v30, v26
    v_add_f32 v27, v27, v37
    v_cvt_pk_bf16_f32 v55, v36, v37
    v_permlane32_swap_b32 v30, v26
    v_mfma_f32_16x16x32_bf16 v[144:147], a[132:135], v[48:51], v[144:147]
    s_waitcnt lgkmcnt(8)
    ds_read_b64_tr_b16 a[132:133], v5 offset:36992
    ds_read_b64_tr_b16 a[134:135], v5 offset:43136
    v_add_f32 v26, v26, v30
    v_mov_b32 v30, v26
    v_cmp_nge_f32 vcc, 0x44800000, v27
    v_mfma_f32_16x16x32_bf16 v[160:163], a[136:139], v[48:51], v[160:163]
    s_waitcnt lgkmcnt(8)
    ds_read_b64_tr_b16 a[136:137], v2 offset:37120
    ds_read_b64_tr_b16 a[138:139], v2 offset:43264
    v_permlane16_swap_b32 v30, v26
    v_add_f32 v26, v26, v30
    v_rcp_f32 v26, v26
    v_mfma_f32_16x16x32_bf16 v[176:179], a[140:143], v[48:51], v[176:179]
    s_waitcnt lgkmcnt(8)
    ds_read_b64_tr_b16 a[140:141], v3 offset:37120
    ds_read_b64_tr_b16 a[142:143], v3 offset:43264
    v_mul_f32 v128, v128, v26
    v_mul_f32 v129, v129, v26
    v_mul_f32 v130, v130, v26
    v_mul_f32 v131, v131, v26
    v_mul_f32 v144, v144, v26
    v_mul_f32 v145, v145, v26
    v_mul_f32 v146, v146, v26
    v_mul_f32 v147, v147, v26
    v_cvt_pk_bf16_f32 v128, v128, v129
    v_cvt_pk_bf16_f32 v129, v130, v131
    v_mul_f32 v160, v160, v26
    v_mul_f32 v161, v161, v26
    v_mfma_f32_16x16x32_bf16 v[192:195], a[144:147], v[48:51], v[192:195]
    s_waitcnt lgkmcnt(8)
    ds_read_b64_tr_b16 a[144:145], v4 offset:37120
    ds_read_b64_tr_b16 a[146:147], v4 offset:43264
    ds_write_b64 v16, v[128:129] offset:0
    v_mul_f32 v162, v162, v26
    v_mul_f32 v163, v163, v26
    v_cvt_pk_bf16_f32 v144, v144, v145
    v_cvt_pk_bf16_f32 v145, v146, v147
    v_mul_f32 v176, v176, v26
    v_mfma_f32_16x16x32_bf16 v[208:211], a[148:151], v[48:51], v[208:211]
    s_waitcnt lgkmcnt(9)
    ds_read_b64_tr_b16 a[148:149], v5 offset:37120
    ds_read_b64_tr_b16 a[150:151], v5 offset:43264
    ds_write_b64 v38, v[144:145] offset:0
    v_mul_f32 v177, v177, v26
    v_mul_f32 v178, v178, v26
    v_mul_f32 v179, v179, v26
    v_cvt_pk_bf16_f32 v160, v160, v161
    v_cvt_pk_bf16_f32 v161, v162, v163
    v_xor_b32 v38, 64, v16
    v_mfma_f32_16x16x32_bf16 v[224:227], a[128:131], v[48:51], v[224:227]
    s_waitcnt lgkmcnt(10)
    ds_read_b64_tr_b16 a[128:129], v2 offset:12288
    ds_read_b64_tr_b16 a[130:131], v2 offset:18432
    ds_write_b64 v38, v[160:161] offset:0
    v_mul_f32 v192, v192, v26
    v_mul_f32 v193, v193, v26
    v_mul_f32 v194, v194, v26
    v_mul_f32 v195, v195, v26
    v_cvt_pk_bf16_f32 v176, v176, v177
    v_mfma_f32_16x16x32_bf16 v[240:243], a[132:135], v[48:51], v[240:243]
    s_waitcnt lgkmcnt(11)
    ds_read_b64_tr_b16 a[132:133], v3 offset:12288
    ds_read_b64_tr_b16 a[134:135], v3 offset:18432
    v_cvt_pk_bf16_f32 v177, v178, v179
    v_xor_b32 v38, 96, v16
    v_mul_f32 v208, v208, v26
    v_mul_f32 v209, v209, v26
    v_mul_f32 v210, v210, v26
    v_mul_f32 v211, v211, v26
    v_mfma_f32_16x16x32_bf16 a[152:155], a[136:139], v[48:51], a[152:155]
    s_waitcnt lgkmcnt(11)
    ds_write_b64 v38, v[176:177] offset:0
    ds_read_b128 a[0:3], v17 offset:0
    ds_read_b64_tr_b16 a[136:137], v4 offset:12288
    ds_read_b64_tr_b16 a[138:139], v4 offset:18432
    v_cvt_pk_bf16_f32 v192, v192, v193
    v_cvt_pk_bf16_f32 v193, v194, v195
    v_mul_f32 v224, v224, v26
    v_mul_f32 v225, v225, v26
    v_mfma_f32_16x16x32_bf16 a[168:171], a[140:143], v[48:51], a[168:171]
    s_waitcnt lgkmcnt(13)
    ds_read_b128 a[4:7], v17 offset:1024
    ds_write_b64 v16, v[192:193] offset:8192
    ds_read_b64_tr_b16 a[140:141], v5 offset:12288
    ds_read_b64_tr_b16 a[142:143], v5 offset:18432
    v_mul_f32 v226, v226, v26
    v_mul_f32 v227, v227, v26
    v_cvt_pk_bf16_f32 v208, v208, v209
    v_cvt_pk_bf16_f32 v209, v210, v211
    v_xor_b32 v38, 32, v16
    v_mfma_f32_16x16x32_bf16 a[184:187], a[144:147], v[48:51], a[184:187]
    s_waitcnt lgkmcnt(14)
    ds_write_b64 v38, v[208:209] offset:8192
    ds_read_b64_tr_b16 a[144:145], v2 offset:12416
    ds_read_b64_tr_b16 a[146:147], v2 offset:18560
    v_mul_f32 v240, v240, v26
    v_mul_f32 v241, v241, v26
    v_mul_f32 v242, v242, v26
    v_mul_f32 v243, v243, v26
    v_cvt_pk_bf16_f32 v224, v224, v225
    v_mfma_f32_16x16x32_bf16 a[200:203], a[148:151], v[48:51], a[200:203]
    s_waitcnt lgkmcnt(14)
    ds_read_b64_tr_b16 a[148:149], v3 offset:12416
    ds_read_b64_tr_b16 a[150:151], v3 offset:18560
    s_waitcnt lgkmcnt(11)
    buffer_store_dwordx4 a[0:3], v12, s[16:19], s28 offen offset:0 nt
    v_cvt_pk_bf16_f32 v225, v226, v227
    v_xor_b32 v38, 64, v16
    v_accvgpr_read_b32 v128, a152
    v_accvgpr_read_b32 v129, a153
    v_accvgpr_read_b32 v130, a154
    v_mfma_f32_16x16x32_bf16 v[132:135], a[128:131], v[44:47], v[132:135]
    ds_write_b64 v38, v[224:225] offset:8192
    ds_read_b64_tr_b16 a[128:129], v4 offset:12416
    ds_read_b64_tr_b16 a[130:131], v4 offset:18560
    v_accvgpr_read_b32 v131, a155
    v_mul_f32 v128, v128, v26
    v_mul_f32 v129, v129, v26
    v_mul_f32 v130, v130, v26
    v_mul_f32 v131, v131, v26
    v_cvt_pk_bf16_f32 v240, v240, v241
    v_mfma_f32_16x16x32_bf16 v[148:151], a[132:135], v[44:47], v[148:151]
    s_waitcnt lgkmcnt(12)
    ds_read_b64_tr_b16 a[132:133], v5 offset:12416
    ds_read_b64_tr_b16 a[134:135], v5 offset:18560
    v_cvt_pk_bf16_f32 v241, v242, v243
    v_xor_b32 v38, 96, v16
    v_accvgpr_read_b32 v144, a168
    v_accvgpr_read_b32 v145, a169
    v_accvgpr_read_b32 v146, a170
    v_accvgpr_read_b32 v147, a171
    v_mfma_f32_16x16x32_bf16 v[164:167], a[136:139], v[44:47], v[164:167]
    s_waitcnt lgkmcnt(10)
    ds_write_b64 v38, v[240:241] offset:8192
    ds_read_b64_tr_b16 a[136:137], v2 offset:12544
    ds_read_b64_tr_b16 a[138:139], v2 offset:18688
    ds_read_b128 a[32:35], v17 offset:8192
    v_mul_f32 v144, v144, v26
    v_mul_f32 v145, v145, v26
    v_mul_f32 v146, v146, v26
    v_mul_f32 v147, v147, v26
    v_mfma_f32_16x16x32_bf16 v[180:183], a[140:143], v[44:47], v[180:183]
    s_waitcnt lgkmcnt(11)
    ds_read_b128 a[36:39], v17 offset:9216
    buffer_store_dwordx4 a[4:7], v12, s[16:19], s28 offen offset:3072 nt
    ds_read_b64_tr_b16 a[140:141], v3 offset:12544
    ds_read_b64_tr_b16 a[142:143], v3 offset:18688
    v_cvt_pk_bf16_f32 v128, v128, v129
    v_cvt_pk_bf16_f32 v129, v130, v131
    v_accvgpr_read_b32 v160, a184
    v_accvgpr_read_b32 v161, a185
    v_mfma_f32_16x16x32_bf16 v[196:199], a[144:147], v[44:47], v[196:199]
    s_waitcnt lgkmcnt(12)
    ds_write_b64 v16, v[128:129] offset:0
    ds_read_b64_tr_b16 a[144:145], v4 offset:12544
    ds_read_b64_tr_b16 a[146:147], v4 offset:18688
    v_accvgpr_read_b32 v162, a186
    v_accvgpr_read_b32 v163, a187
    v_mul_f32 v160, v160, v26
    v_mul_f32 v161, v161, v26
    v_mul_f32 v162, v162, v26
    v_mul_f32 v163, v163, v26
    v_mfma_f32_16x16x32_bf16 v[212:215], a[148:151], v[44:47], v[212:215]
    s_waitcnt lgkmcnt(12)
    ds_read_b64_tr_b16 a[148:149], v5 offset:12544
    ds_read_b64_tr_b16 a[150:151], v5 offset:18688
    v_cvt_pk_bf16_f32 v144, v144, v145
    v_cvt_pk_bf16_f32 v145, v146, v147
    v_xor_b32 v38, 32, v16
    v_accvgpr_read_b32 v176, a200
    v_accvgpr_read_b32 v177, a201
    v_accvgpr_read_b32 v178, a202
    v_mfma_f32_16x16x32_bf16 v[228:231], a[128:131], v[44:47], v[228:231]
    s_waitcnt lgkmcnt(12)
    ds_write_b64 v38, v[144:145] offset:0
    ds_read_b64_tr_b16 a[128:129], v2 offset:36864
    ds_read_b64_tr_b16 a[130:131], v2 offset:43008
    s_waitcnt lgkmcnt(11)
    buffer_store_dwordx4 a[32:35], v12, s[16:19], s28 offen offset:128 nt
    v_accvgpr_read_b32 v179, a203
    v_mul_f32 v176, v176, v26
    v_mul_f32 v177, v177, v26
    v_mul_f32 v178, v178, v26
    v_mfma_f32_16x16x32_bf16 v[244:247], a[132:135], v[44:47], v[244:247]
    ds_read_b64_tr_b16 a[132:133], v3 offset:36864
    ds_read_b64_tr_b16 a[134:135], v3 offset:43008
    s_waitcnt lgkmcnt(12)
    buffer_store_dwordx4 a[36:39], v12, s[16:19], s28 offen offset:3200 nt
    v_mul_f32 v179, v179, v26
    v_cvt_pk_bf16_f32 v160, v160, v161
    v_cvt_pk_bf16_f32 v161, v162, v163
    v_xor_b32 v38, 64, v16
    v_cvt_pk_bf16_f32 v176, v176, v177
    v_cvt_pk_bf16_f32 v177, v178, v179
    v_mfma_f32_16x16x32_bf16 a[156:159], a[136:139], v[44:47], a[156:159]
    s_waitcnt lgkmcnt(10)
    ds_write_b64 v38, v[160:161] offset:0
    ds_read_b64_tr_b16 a[136:137], v4 offset:36864
    ds_read_b64_tr_b16 a[138:139], v4 offset:43008
    v_xor_b32 v38, 96, v16
    v_fma_f32 v112, v112, s23, -v20
    v_fma_f32 v113, v113, s23, -v20
    v_fma_f32 v114, v114, s23, -v20
    v_fma_f32 v115, v115, s23, -v20
    v_mfma_f32_16x16x32_bf16 a[172:175], a[140:143], v[44:47], a[172:175]
    s_waitcnt lgkmcnt(10)
    ds_write_b64 v38, v[176:177] offset:0
    ds_read_b128 a[64:67], v17 offset:0
    ds_read_b64_tr_b16 a[140:141], v5 offset:36864
    ds_read_b64_tr_b16 a[142:143], v5 offset:43008
    v_xor_b32 v38, 32, v16
    v_exp_f32 v34, v112
    v_fma_f32 v116, v116, s23, -v20
    v_mfma_f32_16x16x32_bf16 a[188:191], a[144:147], v[44:47], a[188:191]
    s_waitcnt lgkmcnt(12)
    ds_read_b128 a[68:71], v17 offset:1024
    ds_read_b64_tr_b16 a[144:145], v2 offset:36992
    ds_read_b64_tr_b16 a[146:147], v2 offset:43136
    v_exp_f32 v35, v113
    v_fma_f32 v117, v117, s23, -v20
    v_exp_f32 v36, v114
    v_mfma_f32_16x16x32_bf16 a[204:207], a[148:151], v[44:47], a[204:207]
    s_waitcnt lgkmcnt(12)
    ds_read_b64_tr_b16 a[148:149], v3 offset:36992
    ds_read_b64_tr_b16 a[150:151], v3 offset:43136
    v_fma_f32 v118, v118, s23, -v20
    v_add_f32 v28, v34, v35
    v_cvt_pk_bf16_f32 v64, v34, v35
    v_exp_f32 v37, v115
    v_fma_f32 v119, v119, s23, -v20
    v_add_f32 v28, v28, v36
    s_cbranch_vccnz Lrs19
Lrr20:
    v_mfma_f32_16x16x32_bf16 v[132:135], a[128:131], v[52:55], v[132:135]
    s_waitcnt lgkmcnt(12)
    s_waitcnt lgkmcnt(7)
    buffer_store_dwordx4 a[64:67], v12, s[16:19], s28 offen offset:256 nt
    ds_read_b64_tr_b16 a[128:129], v4 offset:36992
    ds_read_b64_tr_b16 a[130:131], v4 offset:43136
    v_add_f32 v23, v23, v27
    v_mov_b32 v27, v23
    v_mov_b32 v31, v27
    v_exp_f32 v34, v116
    v_mfma_f32_16x16x32_bf16 v[148:151], a[132:135], v[52:55], v[148:151]
    s_waitcnt lgkmcnt(6)
    buffer_store_dwordx4 a[68:71], v12, s[16:19], s28 offen offset:3328 nt
    ds_read_b64_tr_b16 a[132:133], v5 offset:36992
    ds_read_b64_tr_b16 a[134:135], v5 offset:43136
    v_permlane32_swap_b32 v31, v27
    v_add_f32 v27, v27, v31
    v_mov_b32 v31, v27
    v_add_f32 v28, v28, v37
    v_cvt_pk_bf16_f32 v65, v36, v37
    v_mfma_f32_16x16x32_bf16 v[164:167], a[136:139], v[52:55], v[164:167]
    ds_read_b64_tr_b16 a[136:137], v2 offset:37120
    ds_read_b64_tr_b16 a[138:139], v2 offset:43264
    v_permlane16_swap_b32 v31, v27
    v_add_f32 v27, v27, v31
    v_rcp_f32 v27, v27
    v_exp_f32 v35, v117
    v_mfma_f32_16x16x32_bf16 v[180:183], a[140:143], v[52:55], v[180:183]
    s_waitcnt lgkmcnt(8)
    ds_read_b64_tr_b16 a[140:141], v3 offset:37120
    ds_read_b64_tr_b16 a[142:143], v3 offset:43264
    v_mul_f32 v132, v132, v27
    v_mul_f32 v133, v133, v27
    v_mul_f32 v134, v134, v27
    v_mul_f32 v135, v135, v27
    v_mul_f32 v148, v148, v27
    v_mul_f32 v149, v149, v27
    v_mul_f32 v150, v150, v27
    v_mfma_f32_16x16x32_bf16 v[196:199], a[144:147], v[52:55], v[196:199]
    s_waitcnt lgkmcnt(8)
    ds_read_b64_tr_b16 a[144:145], v4 offset:37120
    ds_read_b64_tr_b16 a[146:147], v4 offset:43264
    v_mul_f32 v151, v151, v27
    v_cvt_pk_bf16_f32 v132, v132, v133
    v_cvt_pk_bf16_f32 v133, v134, v135
    v_mul_f32 v164, v164, v27
    v_mul_f32 v165, v165, v27
    v_mul_f32 v166, v166, v27
    v_mfma_f32_16x16x32_bf16 v[212:215], a[148:151], v[52:55], v[212:215]
    s_waitcnt lgkmcnt(8)
    ds_write_b64 v16, v[132:133] offset:2048
    ds_read_b64_tr_b16 a[148:149], v5 offset:37120
    ds_read_b64_tr_b16 a[150:151], v5 offset:43264
    v_mul_f32 v167, v167, v27
    v_cvt_pk_bf16_f32 v148, v148, v149
    v_cvt_pk_bf16_f32 v149, v150, v151
    v_mul_f32 v180, v180, v27
    v_mul_f32 v181, v181, v27
    v_mfma_f32_16x16x32_bf16 v[228:231], a[128:131], v[52:55], v[228:231]
    s_waitcnt lgkmcnt(9)
    ds_write_b64 v38, v[148:149] offset:2048
    ds_read_b64_tr_b16 a[128:129], v2 offset:12288
    ds_read_b64_tr_b16 a[130:131], v2 offset:18432
    v_mul_f32 v182, v182, v27
    v_mul_f32 v183, v183, v27
    v_cvt_pk_bf16_f32 v164, v164, v165
    v_cvt_pk_bf16_f32 v165, v166, v167
    v_xor_b32 v38, 64, v16
    v_mul_f32 v196, v196, v27
    v_mfma_f32_16x16x32_bf16 v[244:247], a[132:135], v[52:55], v[244:247]
    s_waitcnt lgkmcnt(10)
    ds_write_b64 v38, v[164:165] offset:2048
    ds_read_b64_tr_b16 a[132:133], v3 offset:12288
    ds_read_b64_tr_b16 a[134:135], v3 offset:18432
    v_mul_f32 v197, v197, v27
    v_mul_f32 v198, v198, v27
    v_mul_f32 v199, v199, v27
    v_cvt_pk_bf16_f32 v180, v180, v181
    v_cvt_pk_bf16_f32 v181, v182, v183
    v_mfma_f32_16x16x32_bf16 a[156:159], a[136:139], v[52:55], a[156:159]
    s_waitcnt lgkmcnt(11)
    ds_read_b64_tr_b16 a[136:137], v4 offset:12288
    ds_read_b64_tr_b16 a[138:139], v4 offset:18432
    v_xor_b32 v38, 96, v16
    v_mul_f32 v212, v212, v27
    v_mul_f32 v213, v213, v27
    v_mul_f32 v214, v214, v27
    v_mul_f32 v215, v215, v27
    v_cvt_pk_bf16_f32 v196, v196, v197
    v_mfma_f32_16x16x32_bf16 a[172:175], a[140:143], v[52:55], a[172:175]
    s_waitcnt lgkmcnt(11)
    ds_write_b64 v38, v[180:181] offset:2048
    ds_read_b128 a[8:11], v17 offset:2048
    ds_read_b64_tr_b16 a[140:141], v5 offset:12288
    ds_read_b64_tr_b16 a[142:143], v5 offset:18432
    v_cvt_pk_bf16_f32 v197, v198, v199
    v_mul_f32 v228, v228, v27
    v_mul_f32 v229, v229, v27
    v_mul_f32 v230, v230, v27
    v_mfma_f32_16x16x32_bf16 a[188:191], a[144:147], v[52:55], a[188:191]
    s_waitcnt lgkmcnt(12)
    ds_read_b128 a[12:15], v17 offset:3072
    ds_write_b64 v16, v[196:197] offset:10240
    ds_read_b64_tr_b16 a[144:145], v2 offset:12416
    ds_read_b64_tr_b16 a[146:147], v2 offset:18560
    v_mul_f32 v231, v231, v27
    v_cvt_pk_bf16_f32 v212, v212, v213
    v_cvt_pk_bf16_f32 v213, v214, v215
    v_xor_b32 v38, 32, v16
    v_mul_f32 v244, v244, v27
    v_mfma_f32_16x16x32_bf16 a[204:207], a[148:151], v[52:55], a[204:207]
    s_waitcnt lgkmcnt(13)
    ds_write_b64 v38, v[212:213] offset:10240
    ds_read_b64_tr_b16 a[148:149], v3 offset:12416
    ds_read_b64_tr_b16 a[150:151], v3 offset:18560
    v_mul_f32 v245, v245, v27
    v_mul_f32 v246, v246, v27
    v_mul_f32 v247, v247, v27
    v_cvt_pk_bf16_f32 v228, v228, v229
    v_cvt_pk_bf16_f32 v229, v230, v231
    v_mfma_f32_16x16x32_bf16 v[136:139], a[128:131], v[56:59], v[136:139]
    s_waitcnt lgkmcnt(13)
    s_waitcnt lgkmcnt(9)
    buffer_store_dwordx4 a[8:11], v12, s[16:19], s29 offen offset:0 nt
    ds_read_b64_tr_b16 a[128:129], v4 offset:12416
    ds_read_b64_tr_b16 a[130:131], v4 offset:18560
    v_xor_b32 v38, 64, v16
    v_accvgpr_read_b32 v132, a156
    v_accvgpr_read_b32 v133, a157
    v_accvgpr_read_b32 v134, a158
    v_accvgpr_read_b32 v135, a159
    v_mfma_f32_16x16x32_bf16 v[152:155], a[132:135], v[56:59], v[152:155]
    ds_write_b64 v38, v[228:229] offset:10240
    ds_read_b64_tr_b16 a[132:133], v5 offset:12416
    ds_read_b64_tr_b16 a[134:135], v5 offset:18560
    v_mul_f32 v132, v132, v27
    v_mul_f32 v133, v133, v27
    v_mul_f32 v134, v134, v27
    v_mul_f32 v135, v135, v27
    v_cvt_pk_bf16_f32 v244, v244, v245
    v_cvt_pk_bf16_f32 v245, v246, v247
    v_mfma_f32_16x16x32_bf16 v[168:171], a[136:139], v[56:59], v[168:171]
    s_waitcnt lgkmcnt(12)
    ds_read_b64_tr_b16 a[136:137], v2 offset:12544
    ds_read_b64_tr_b16 a[138:139], v2 offset:18688
    s_waitcnt lgkmcnt(13)
    buffer_store_dwordx4 a[12:15], v12, s[16:19], s29 offen offset:3072 nt
    v_xor_b32 v38, 96, v16
    v_accvgpr_read_b32 v148, a172
    v_accvgpr_read_b32 v149, a173
    v_accvgpr_read_b32 v150, a174
    v_accvgpr_read_b32 v151, a175
    v_mfma_f32_16x16x32_bf16 v[184:187], a[140:143], v[56:59], v[184:187]
    s_waitcnt lgkmcnt(10)
    ds_write_b64 v38, v[244:245] offset:10240
    ds_read_b128 a[40:43], v17 offset:10240
    ds_read_b64_tr_b16 a[140:141], v3 offset:12544
    ds_read_b64_tr_b16 a[142:143], v3 offset:18688
    v_mul_f32 v148, v148, v27
    v_mul_f32 v149, v149, v27
    v_mul_f32 v150, v150, v27
    v_mul_f32 v151, v151, v27
    v_mfma_f32_16x16x32_bf16 v[200:203], a[144:147], v[56:59], v[200:203]
    s_waitcnt lgkmcnt(11)
    ds_read_b128 a[44:47], v17 offset:11264
    ds_read_b64_tr_b16 a[144:145], v4 offset:12544
    ds_read_b64_tr_b16 a[146:147], v4 offset:18688
    v_cvt_pk_bf16_f32 v132, v132, v133
    v_cvt_pk_bf16_f32 v133, v134, v135
    v_accvgpr_read_b32 v164, a188
    v_accvgpr_read_b32 v165, a189
    v_accvgpr_read_b32 v166, a190
    v_mfma_f32_16x16x32_bf16 v[216:219], a[148:151], v[56:59], v[216:219]
    s_waitcnt lgkmcnt(12)
    ds_write_b64 v16, v[132:133] offset:2048
    ds_read_b64_tr_b16 a[148:149], v5 offset:12544
    ds_read_b64_tr_b16 a[150:151], v5 offset:18688
    v_accvgpr_read_b32 v167, a191
    v_mul_f32 v164, v164, v27
    v_mul_f32 v165, v165, v27
    v_mul_f32 v166, v166, v27
    v_mul_f32 v167, v167, v27
    v_cvt_pk_bf16_f32 v148, v148, v149
    v_mfma_f32_16x16x32_bf16 v[232:235], a[128:131], v[56:59], v[232:235]
    s_waitcnt lgkmcnt(12)
    ds_read_b64_tr_b16 a[128:129], v2 offset:36864
    ds_read_b64_tr_b16 a[130:131], v2 offset:43008
    s_waitcnt lgkmcnt(10)
    buffer_store_dwordx4 a[40:43], v12, s[16:19], s29 offen offset:128 nt
    v_cvt_pk_bf16_f32 v149, v150, v151
    v_xor_b32 v38, 32, v16
    v_accvgpr_read_b32 v180, a204
    v_accvgpr_read_b32 v181, a205
    v_accvgpr_read_b32 v182, a206
    v_mfma_f32_16x16x32_bf16 v[248:251], a[132:135], v[56:59], v[248:251]
    ds_write_b64 v38, v[148:149] offset:2048
    ds_read_b64_tr_b16 a[132:133], v3 offset:36864
    ds_read_b64_tr_b16 a[134:135], v3 offset:43008
    s_waitcnt lgkmcnt(10)
    buffer_store_dwordx4 a[44:47], v12, s[16:19], s29 offen offset:3200 nt
    v_accvgpr_read_b32 v183, a207
    v_mul_f32 v180, v180, v27
    v_mul_f32 v181, v181, v27
    v_mul_f32 v182, v182, v27
    v_mfma_f32_16x16x32_bf16 a[160:163], a[136:139], v[56:59], a[160:163]
    ds_read_b64_tr_b16 a[136:137], v4 offset:36864
    ds_read_b64_tr_b16 a[138:139], v4 offset:43008
    v_mul_f32 v183, v183, v27
    v_cvt_pk_bf16_f32 v164, v164, v165
    v_cvt_pk_bf16_f32 v165, v166, v167
    v_xor_b32 v38, 64, v16
    v_cvt_pk_bf16_f32 v180, v180, v181
    v_cvt_pk_bf16_f32 v181, v182, v183
    v_mfma_f32_16x16x32_bf16 a[176:179], a[140:143], v[56:59], a[176:179]
    s_waitcnt lgkmcnt(10)
    ds_write_b64 v38, v[164:165] offset:2048
    ds_read_b64_tr_b16 a[140:141], v5 offset:36864
    ds_read_b64_tr_b16 a[142:143], v5 offset:43008
    v_xor_b32 v38, 96, v16
    v_add_f32 v28, v28, v34
    v_exp_f32 v36, v118
    v_add_f32 v28, v28, v35
    v_cvt_pk_bf16_f32 v66, v34, v35
    v_mfma_f32_16x16x32_bf16 a[192:195], a[144:147], v[56:59], a[192:195]
    s_waitcnt lgkmcnt(10)
    ds_write_b64 v38, v[180:181] offset:2048
    ds_read_b128 a[72:75], v17 offset:2048
    ds_read_b64_tr_b16 a[144:145], v2 offset:36992
    ds_read_b64_tr_b16 a[146:147], v2 offset:43136
    v_exp_f32 v37, v119
    v_add_f32 v28, v28, v36
    v_add_f32 v28, v28, v37
    v_mfma_f32_16x16x32_bf16 a[208:211], a[148:151], v[56:59], a[208:211]
    s_waitcnt lgkmcnt(12)
    ds_read_b128 a[76:79], v17 offset:3072
    ds_read_b64_tr_b16 a[148:149], v3 offset:36992
    ds_read_b64_tr_b16 a[150:151], v3 offset:43136
    v_cvt_pk_bf16_f32 v67, v36, v37
    v_cmp_nge_f32 vcc, 0x44800000, v28
    v_xor_b32 v38, 32, v16
    v_fma_f32 v120, v120, s23, -v21
    v_fma_f32 v121, v121, s23, -v21
    s_cbranch_vccnz Lrs21
Lrr22:
    v_mfma_f32_16x16x32_bf16 v[136:139], a[128:131], v[64:67], v[136:139]
    s_waitcnt lgkmcnt(12)
    ds_read_b64_tr_b16 a[128:129], v4 offset:36992
    ds_read_b64_tr_b16 a[130:131], v4 offset:43136
    v_add_f32 v24, v24, v28
    v_mov_b32 v28, v24
    v_mov_b32 v32, v28
    v_fma_f32 v122, v122, s23, -v21
    v_fma_f32 v123, v123, s23, -v21
    v_permlane32_swap_b32 v32, v28
    v_add_f32 v28, v28, v32
    v_mfma_f32_16x16x32_bf16 v[152:155], a[132:135], v[64:67], v[152:155]
    s_waitcnt lgkmcnt(12)
    s_waitcnt lgkmcnt(7)
    buffer_store_dwordx4 a[72:75], v12, s[16:19], s29 offen offset:256 nt
    ds_read_b64_tr_b16 a[132:133], v5 offset:36992
    s_waitcnt lgkmcnt(5)
    buffer_store_dwordx4 a[76:79], v12, s[16:19], s29 offen offset:3328 nt
    ds_read_b64_tr_b16 a[134:135], v5 offset:43136
    v_mov_b32 v32, v28
    v_exp_f32 v34, v120
    v_fma_f32 v124, v124, s23, -v21
    v_mfma_f32_16x16x32_bf16 v[168:171], a[136:139], v[64:67], v[168:171]
    ds_read_b64_tr_b16 a[136:137], v2 offset:37120
    ds_read_b64_tr_b16 a[138:139], v2 offset:43264
    v_permlane16_swap_b32 v32, v28
    v_add_f32 v28, v28, v32
    v_rcp_f32 v28, v28
    v_exp_f32 v35, v121
    v_mfma_f32_16x16x32_bf16 v[184:187], a[140:143], v[64:67], v[184:187]
    ds_read_b64_tr_b16 a[140:141], v3 offset:37120
    ds_read_b64_tr_b16 a[142:143], v3 offset:43264
    v_mul_f32 v136, v136, v28
    v_mul_f32 v137, v137, v28
    v_mul_f32 v138, v138, v28
    v_mul_f32 v139, v139, v28
    v_mul_f32 v152, v152, v28
    v_mul_f32 v153, v153, v28
    v_mfma_f32_16x16x32_bf16 v[200:203], a[144:147], v[64:67], v[200:203]
    s_waitcnt lgkmcnt(8)
    ds_read_b64_tr_b16 a[144:145], v4 offset:37120
    ds_read_b64_tr_b16 a[146:147], v4 offset:43264
    v_mul_f32 v154, v154, v28
    v_mul_f32 v155, v155, v28
    v_cvt_pk_bf16_f32 v136, v136, v137
    v_cvt_pk_bf16_f32 v137, v138, v139
    v_mul_f32 v168, v168, v28
    v_mul_f32 v169, v169, v28
    v_mul_f32 v170, v170, v28
    v_mfma_f32_16x16x32_bf16 v[216:219], a[148:151], v[64:67], v[216:219]
    s_waitcnt lgkmcnt(8)
    ds_write_b64 v16, v[136:137] offset:4096
    ds_read_b64_tr_b16 a[148:149], v5 offset:37120
    ds_read_b64_tr_b16 a[150:151], v5 offset:43264
    v_mul_f32 v171, v171, v28
    v_cvt_pk_bf16_f32 v152, v152, v153
    v_cvt_pk_bf16_f32 v153, v154, v155
    v_mul_f32 v184, v184, v28
    v_mul_f32 v185, v185, v28
    v_mfma_f32_16x16x32_bf16 v[232:235], a[128:131], v[64:67], v[232:235]
    s_waitcnt lgkmcnt(9)
    ds_write_b64 v38, v[152:153] offset:4096
    ds_read_b64_tr_b16 a[128:129], v2 offset:12288
    ds_read_b64_tr_b16 a[130:131], v2 offset:18432
    v_mul_f32 v186, v186, v28
    v_mul_f32 v187, v187, v28
    v_cvt_pk_bf16_f32 v168, v168, v169
    v_cvt_pk_bf16_f32 v169, v170, v171
    v_xor_b32 v38, 64, v16
    v_mfma_f32_16x16x32_bf16 v[248:251], a[132:135], v[64:67], v[248:251]
    s_waitcnt lgkmcnt(10)
    ds_write_b64 v38, v[168:169] offset:4096
    ds_read_b64_tr_b16 a[132:133], v3 offset:12288
    ds_read_b64_tr_b16 a[134:135], v3 offset:18432
    v_mul_f32 v200, v200, v28
    v_mul_f32 v201, v201, v28
    v_mul_f32 v202, v202, v28
    v_mul_f32 v203, v203, v28
    v_cvt_pk_bf16_f32 v184, v184, v185
    v_mfma_f32_16x16x32_bf16 a[160:163], a[136:139], v[64:67], a[160:163]
    s_waitcnt lgkmcnt(11)
    ds_read_b64_tr_b16 a[136:137], v4 offset:12288
    ds_read_b64_tr_b16 a[138:139], v4 offset:18432
    v_cvt_pk_bf16_f32 v185, v186, v187
    v_xor_b32 v38, 96, v16
    v_mul_f32 v216, v216, v28
    v_mul_f32 v217, v217, v28
    v_mul_f32 v218, v218, v28
    v_mul_f32 v219, v219, v28
    v_cvt_pk_bf16_f32 v200, v200, v201
    v_mfma_f32_16x16x32_bf16 a[176:179], a[140:143], v[64:67], a[176:179]
    s_waitcnt lgkmcnt(11)
    ds_write_b64 v38, v[184:185] offset:4096
    ds_read_b128 a[16:19], v17 offset:4096
    ds_read_b64_tr_b16 a[140:141], v5 offset:12288
    ds_read_b64_tr_b16 a[142:143], v5 offset:18432
    v_cvt_pk_bf16_f32 v201, v202, v203
    v_mul_f32 v232, v232, v28
    v_mul_f32 v233, v233, v28
    v_mul_f32 v234, v234, v28
    v_mfma_f32_16x16x32_bf16 a[192:195], a[144:147], v[64:67], a[192:195]
    s_waitcnt lgkmcnt(12)
    ds_read_b128 a[20:23], v17 offset:5120
    ds_write_b64 v16, v[200:201] offset:12288
    ds_read_b64_tr_b16 a[144:145], v2 offset:12416
    ds_read_b64_tr_b16 a[146:147], v2 offset:18560
    v_mul_f32 v235, v235, v28
    v_cvt_pk_bf16_f32 v216, v216, v217
    v_cvt_pk_bf16_f32 v217, v218, v219
    v_xor_b32 v38, 32, v16
    v_mfma_f32_16x16x32_bf16 a[208:211], a[148:151], v[64:67], a[208:211]
    s_waitcnt lgkmcnt(13)
    ds_write_b64 v38, v[216:217] offset:12288
    ds_read_b64_tr_b16 a[148:149], v3 offset:12416
    ds_read_b64_tr_b16 a[150:151], v3 offset:18560
    v_mul_f32 v248, v248, v28
    v_mul_f32 v249, v249, v28
    v_mul_f32 v250, v250, v28
    v_mul_f32 v251, v251, v28
    v_cvt_pk_bf16_f32 v232, v232, v233
    v_cvt_pk_bf16_f32 v233, v234, v235
    v_mfma_f32_16x16x32_bf16 v[140:143], a[128:131], v[60:63], v[140:143]
    s_waitcnt lgkmcnt(13)
    s_waitcnt lgkmcnt(9)
    buffer_store_dwordx4 a[16:19], v12, s[16:19], s30 offen offset:0 nt
    ds_read_b64_tr_b16 a[128:129], v4 offset:12416
    ds_read_b64_tr_b16 a[130:131], v4 offset:18560
    v_xor_b32 v38, 64, v16
    v_accvgpr_read_b32 v136, a160
    v_accvgpr_read_b32 v137, a161
    v_accvgpr_read_b32 v138, a162
    v_accvgpr_read_b32 v139, a163
    v_mfma_f32_16x16x32_bf16 v[156:159], a[132:135], v[60:63], v[156:159]
    ds_write_b64 v38, v[232:233] offset:12288
    ds_read_b64_tr_b16 a[132:133], v5 offset:12416
    ds_read_b64_tr_b16 a[134:135], v5 offset:18560
    v_mul_f32 v136, v136, v28
    v_mul_f32 v137, v137, v28
    v_mul_f32 v138, v138, v28
    v_mul_f32 v139, v139, v28
    v_cvt_pk_bf16_f32 v248, v248, v249
    v_mfma_f32_16x16x32_bf16 v[172:175], a[136:139], v[60:63], v[172:175]
    s_waitcnt lgkmcnt(12)
    ds_read_b64_tr_b16 a[136:137], v2 offset:12544
    ds_read_b64_tr_b16 a[138:139], v2 offset:18688
    s_waitcnt lgkmcnt(13)
    buffer_store_dwordx4 a[20:23], v12, s[16:19], s30 offen offset:3072 nt
    v_cvt_pk_bf16_f32 v249, v250, v251
    v_fma_f32 v125, v125, s23, -v21
    v_xor_b32 v38, 96, v16
    v_accvgpr_read_b32 v152, a176
    v_accvgpr_read_b32 v153, a177
    v_mfma_f32_16x16x32_bf16 v[188:191], a[140:143], v[60:63], v[188:191]
    s_waitcnt lgkmcnt(10)
    ds_write_b64 v38, v[248:249] offset:12288
    ds_read_b128 a[48:51], v17 offset:12288
    ds_read_b64_tr_b16 a[140:141], v3 offset:12544
    ds_read_b64_tr_b16 a[142:143], v3 offset:18688
    v_accvgpr_read_b32 v154, a178
    v_accvgpr_read_b32 v155, a179
    v_exp_f32 v36, v122
    v_fma_f32 v126, v126, s23, -v21
    v_mfma_f32_16x16x32_bf16 v[204:207], a[144:147], v[60:63], v[204:207]
    s_waitcnt lgkmcnt(11)
    ds_read_b128 a[52:55], v17 offset:13312
    ds_read_b64_tr_b16 a[144:145], v4 offset:12544
    ds_read_b64_tr_b16 a[146:147], v4 offset:18688
    v_mul_f32 v152, v152, v28
    v_mul_f32 v153, v153, v28
    v_mul_f32 v154, v154, v28
    v_mul_f32 v155, v155, v28
    v_cvt_pk_bf16_f32 v136, v136, v137
    v_mfma_f32_16x16x32_bf16 v[220:223], a[148:151], v[60:63], v[220:223]
    s_waitcnt lgkmcnt(12)
    ds_read_b64_tr_b16 a[148:149], v5 offset:12544
    ds_read_b64_tr_b16 a[150:151], v5 offset:18688
    v_cvt_pk_bf16_f32 v137, v138, v139
    v_add_f32 v29, v34, v35
    v_cvt_pk_bf16_f32 v68, v34, v35
    v_accvgpr_read_b32 v168, a192
    v_accvgpr_read_b32 v169, a193
    v_accvgpr_read_b32 v170, a194
    v_mfma_f32_16x16x32_bf16 v[236:239], a[128:131], v[60:63], v[236:239]
    s_waitcnt lgkmcnt(11)
    ds_write_b64 v16, v[136:137] offset:4096
    ds_read_b64_tr_b16 a[128:129], v2 offset:36864
    ds_read_b64_tr_b16 a[130:131], v2 offset:43008
    s_waitcnt lgkmcnt(10)
    buffer_store_dwordx4 a[48:51], v12, s[16:19], s30 offen offset:128 nt
    v_exp_f32 v37, v123
    v_fma_f32 v127, v127, s23, -v21
    v_accvgpr_read_b32 v171, a195
    v_mul_f32 v168, v168, v28
    v_mfma_f32_16x16x32_bf16 v[252:255], a[132:135], v[60:63], v[252:255]
    ds_read_b64_tr_b16 a[132:133], v3 offset:36864
    ds_read_b64_tr_b16 a[134:135], v3 offset:43008
    s_waitcnt lgkmcnt(9)
    buffer_store_dwordx4 a[52:55], v12, s[16:19], s30 offen offset:3200 nt
    v_mul_f32 v169, v169, v28
    v_mul_f32 v170, v170, v28
    v_mul_f32 v171, v171, v28
    v_cvt_pk_bf16_f32 v152, v152, v153
    v_add_f32 v29, v29, v36
    v_mfma_f32_16x16x32_bf16 a[164:167], a[136:139], v[60:63], a[164:167]
    ds_read_b64_tr_b16 a[136:137], v4 offset:36864
    ds_read_b64_tr_b16 a[138:139], v4 offset:43008
    v_exp_f32 v34, v124
    v_cvt_pk_bf16_f32 v153, v154, v155
    v_xor_b32 v38, 32, v16
    v_accvgpr_read_b32 v184, a208
    v_accvgpr_read_b32 v185, a209
    v_mfma_f32_16x16x32_bf16 a[180:183], a[140:143], v[60:63], a[180:183]
    s_waitcnt lgkmcnt(9)
    ds_write_b64 v38, v[152:153] offset:4096
    ds_read_b64_tr_b16 a[140:141], v5 offset:36864
    ds_read_b64_tr_b16 a[142:143], v5 offset:43008
    v_accvgpr_read_b32 v186, a210
    v_add_f32 v29, v29, v37
    v_cvt_pk_bf16_f32 v69, v36, v37
    v_accvgpr_read_b32 v187, a211
    v_mul_f32 v184, v184, v28
    v_mfma_f32_16x16x32_bf16 a[196:199], a[144:147], v[60:63], a[196:199]
    s_waitcnt lgkmcnt(10)
    ds_read_b64_tr_b16 a[144:145], v2 offset:36992
    ds_read_b64_tr_b16 a[146:147], v2 offset:43136
    v_mul_f32 v185, v185, v28
    v_mul_f32 v186, v186, v28
    v_mul_f32 v187, v187, v28
    v_cvt_pk_bf16_f32 v168, v168, v169
    v_cvt_pk_bf16_f32 v169, v170, v171
    v_exp_f32 v35, v125
    v_mfma_f32_16x16x32_bf16 a[212:215], a[148:151], v[60:63], a[212:215]
    s_waitcnt lgkmcnt(9)
    ds_read_b64_tr_b16 a[148:149], v3 offset:36992
    ds_read_b64_tr_b16 a[150:151], v3 offset:43136
    v_xor_b32 v38, 64, v16
    v_cvt_pk_bf16_f32 v184, v184, v185
    v_cvt_pk_bf16_f32 v185, v186, v187
    v_add_f32 v29, v29, v34
    v_exp_f32 v36, v126
    v_add_f32 v29, v29, v35
    v_cvt_pk_bf16_f32 v70, v34, v35
    v_exp_f32 v37, v127
    v_add_f32 v29, v29, v36
    v_add_f32 v29, v29, v37
    v_cvt_pk_bf16_f32 v71, v36, v37
    v_cmp_nge_f32 vcc, 0x44800000, v29
    s_cbranch_vccnz Lrs23
Lrr24:
    v_mfma_f32_16x16x32_bf16 v[140:143], a[128:131], v[68:71], v[140:143]
    s_waitcnt lgkmcnt(9)
    ds_write_b64 v38, v[168:169] offset:4096
    ds_read_b64_tr_b16 a[128:129], v4 offset:36992
    ds_read_b64_tr_b16 a[130:131], v4 offset:43136
    v_xor_b32 v38, 96, v16
    v_add_f32 v25, v25, v29
    v_mov_b32 v29, v25
    v_mov_b32 v33, v29
    v_mfma_f32_16x16x32_bf16 v[156:159], a[132:135], v[68:71], v[156:159]
    s_waitcnt lgkmcnt(10)
    ds_write_b64 v38, v[184:185] offset:4096
    ds_read_b128 a[80:83], v17 offset:4096
    ds_read_b64_tr_b16 a[132:133], v5 offset:36992
    ds_read_b64_tr_b16 a[134:135], v5 offset:43136
    v_permlane32_swap_b32 v33, v29
    v_add_f32 v29, v29, v33
    v_mov_b32 v33, v29
    v_xor_b32 v38, 32, v16
    v_mfma_f32_16x16x32_bf16 v[172:175], a[136:139], v[68:71], v[172:175]
    s_waitcnt lgkmcnt(11)
    ds_read_b128 a[84:87], v17 offset:5120
    ds_read_b64_tr_b16 a[136:137], v2 offset:37120
    ds_read_b64_tr_b16 a[138:139], v2 offset:43264
    v_permlane16_swap_b32 v33, v29
    v_add_f32 v29, v29, v33
    v_rcp_f32 v29, v29
    v_mfma_f32_16x16x32_bf16 v[188:191], a[140:143], v[68:71], v[188:191]
    s_waitcnt lgkmcnt(12)
    ds_read_b64_tr_b16 a[140:141], v3 offset:37120
    ds_read_b64_tr_b16 a[142:143], v3 offset:43264
    v_mul_f32 v140, v140, v29
    v_mul_f32 v141, v141, v29
    v_mul_f32 v142, v142, v29
    v_mul_f32 v143, v143, v29
    v_mul_f32 v156, v156, v29
    v_mul_f32 v157, v157, v29
    v_mfma_f32_16x16x32_bf16 v[204:207], a[144:147], v[68:71], v[204:207]
    s_waitcnt lgkmcnt(12)
    s_waitcnt lgkmcnt(7)
    buffer_store_dwordx4 a[80:83], v12, s[16:19], s30 offen offset:256 nt
    ds_read_b64_tr_b16 a[144:145], v4 offset:37120
    ds_read_b64_tr_b16 a[146:147], v4 offset:43264
    v_mul_f32 v158, v158, v29
    v_mul_f32 v159, v159, v29
    v_cvt_pk_bf16_f32 v140, v140, v141
    v_cvt_pk_bf16_f32 v141, v142, v143
    v_mul_f32 v172, v172, v29
    v_mfma_f32_16x16x32_bf16 v[220:223], a[148:151], v[68:71], v[220:223]
    s_waitcnt lgkmcnt(6)
    buffer_store_dwordx4 a[84:87], v12, s[16:19], s30 offen offset:3328 nt
    ds_write_b64 v16, v[140:141] offset:6144
    ds_read_b64_tr_b16 a[148:149], v5 offset:37120
    ds_read_b64_tr_b16 a[150:151], v5 offset:43264
    v_mul_f32 v173, v173, v29
    v_mul_f32 v174, v174, v29
    v_mul_f32 v175, v175, v29
    v_mfma_f32_16x16x32_bf16 v[236:239], a[128:131], v[68:71], v[236:239]
    v_cvt_pk_bf16_f32 v156, v156, v157
    v_cvt_pk_bf16_f32 v157, v158, v159
    v_mul_f32 v188, v188, v29
    v_mul_f32 v189, v189, v29
    v_mul_f32 v190, v190, v29
    v_mul_f32 v191, v191, v29
    v_cvt_pk_bf16_f32 v172, v172, v173
    v_cvt_pk_bf16_f32 v173, v174, v175
    v_mfma_f32_16x16x32_bf16 v[252:255], a[132:135], v[68:71], v[252:255]
    s_waitcnt lgkmcnt(7)
    ds_write_b64 v38, v[156:157] offset:6144
    v_xor_b32 v38, 64, v16
    v_mul_f32 v204, v204, v29
    v_mul_f32 v205, v205, v29
    v_mul_f32 v206, v206, v29
    v_mul_f32 v207, v207, v29
    v_cvt_pk_bf16_f32 v188, v188, v189
    v_mfma_f32_16x16x32_bf16 a[164:167], a[136:139], v[68:71], a[164:167]
    s_waitcnt lgkmcnt(6)
    ds_write_b64 v38, v[172:173] offset:6144
    v_cvt_pk_bf16_f32 v189, v190, v191
    v_xor_b32 v38, 96, v16
    v_mul_f32 v220, v220, v29
    v_mul_f32 v221, v221, v29
    v_mul_f32 v222, v222, v29
    v_mul_f32 v223, v223, v29
    v_cvt_pk_bf16_f32 v204, v204, v205
    v_mfma_f32_16x16x32_bf16 a[180:183], a[140:143], v[68:71], a[180:183]
    s_waitcnt lgkmcnt(5)
    ds_write_b64 v38, v[188:189] offset:6144
    ds_read_b128 a[24:27], v17 offset:6144
    v_cvt_pk_bf16_f32 v205, v206, v207
    v_mul_f32 v236, v236, v29
    v_mul_f32 v237, v237, v29
    v_mul_f32 v238, v238, v29
    v_mul_f32 v239, v239, v29
    v_cvt_pk_bf16_f32 v220, v220, v221
    v_mfma_f32_16x16x32_bf16 a[196:199], a[144:147], v[68:71], a[196:199]
    s_waitcnt lgkmcnt(4)
    ds_read_b128 a[28:31], v17 offset:7168
    ds_write_b64 v16, v[204:205] offset:14336
    v_cvt_pk_bf16_f32 v221, v222, v223
    v_xor_b32 v38, 32, v16
    v_mul_f32 v252, v252, v29
    v_mul_f32 v253, v253, v29
    v_mul_f32 v254, v254, v29
    v_mfma_f32_16x16x32_bf16 a[212:215], a[148:151], v[68:71], a[212:215]
    ds_write_b64 v38, v[220:221] offset:14336
    v_mul_f32 v255, v255, v29
    v_cvt_pk_bf16_f32 v236, v236, v237
    v_cvt_pk_bf16_f32 v237, v238, v239
    v_xor_b32 v38, 64, v16
    v_accvgpr_read_b32 v140, a164
    v_accvgpr_read_b32 v141, a165
    ds_write_b64 v38, v[236:237] offset:14336
    v_accvgpr_read_b32 v142, a166
    v_accvgpr_read_b32 v143, a167
    v_mul_f32 v140, v140, v29
    v_mul_f32 v141, v141, v29
    v_mul_f32 v142, v142, v29
    v_mul_f32 v143, v143, v29
    v_cvt_pk_bf16_f32 v252, v252, v253
    v_cvt_pk_bf16_f32 v253, v254, v255
    s_waitcnt lgkmcnt(4)
    buffer_store_dwordx4 a[24:27], v12, s[16:19], s31 offen offset:0 nt
    v_xor_b32 v38, 96, v16
    v_accvgpr_read_b32 v156, a180
    v_accvgpr_read_b32 v157, a181
    ds_write_b64 v38, v[252:253] offset:14336
    v_accvgpr_read_b32 v158, a182
    v_accvgpr_read_b32 v159, a183
    v_mul_f32 v156, v156, v29
    v_mul_f32 v157, v157, v29
    v_mul_f32 v158, v158, v29
    v_mul_f32 v159, v159, v29
    v_cvt_pk_bf16_f32 v140, v140, v141
    v_cvt_pk_bf16_f32 v141, v142, v143
    ds_read_b128 a[56:59], v17 offset:14336
    ds_read_b128 a[60:63], v17 offset:15360
    s_waitcnt lgkmcnt(6)
    buffer_store_dwordx4 a[28:31], v12, s[16:19], s31 offen offset:3072 nt
    v_accvgpr_read_b32 v172, a196
    v_accvgpr_read_b32 v173, a197
    ds_write_b64 v16, v[140:141] offset:6144
    v_accvgpr_read_b32 v174, a198
    v_accvgpr_read_b32 v175, a199
    v_mul_f32 v172, v172, v29
    v_mul_f32 v173, v173, v29
    v_mul_f32 v174, v174, v29
    v_mul_f32 v175, v175, v29
    v_cvt_pk_bf16_f32 v156, v156, v157
    v_cvt_pk_bf16_f32 v157, v158, v159
    v_xor_b32 v38, 32, v16
    v_accvgpr_read_b32 v188, a212
    v_accvgpr_read_b32 v189, a213
    ds_write_b64 v38, v[156:157] offset:6144
    v_accvgpr_read_b32 v190, a214
    v_accvgpr_read_b32 v191, a215
    v_mul_f32 v188, v188, v29
    v_mul_f32 v189, v189, v29
    v_mul_f32 v190, v190, v29
    v_mul_f32 v191, v191, v29
    v_cvt_pk_bf16_f32 v172, v172, v173
    v_cvt_pk_bf16_f32 v173, v174, v175
    v_xor_b32 v38, 64, v16
    v_cvt_pk_bf16_f32 v188, v188, v189
    v_cvt_pk_bf16_f32 v189, v190, v191
    ds_write_b64 v38, v[172:173] offset:6144
    s_waitcnt lgkmcnt(4)
    buffer_store_dwordx4 a[56:59], v12, s[16:19], s31 offen offset:128 nt
    v_xor_b32 v38, 96, v16
    ds_write_b64 v38, v[188:189] offset:6144
    ds_read_b128 a[88:91], v17 offset:6144
    ds_read_b128 a[92:95], v17 offset:7168
    s_waitcnt lgkmcnt(6)
    buffer_store_dwordx4 a[60:63], v12, s[16:19], s31 offen offset:3200 nt
    s_waitcnt lgkmcnt(1)
    buffer_store_dwordx4 a[88:91], v12, s[16:19], s31 offen offset:256 nt
    s_waitcnt lgkmcnt(0)
    buffer_store_dwordx4 a[92:95], v12, s[16:19], s31 offen offset:3328 nt
Lend:
    s_endpgm
Ldisp3:
    s_cmp_lg_u32 s25, 1
    s_cbranch_scc1 Ldisp3_1
    buffer_load_dwordx4 a[96:99], v11, s[12:15], s28 offen offset:256 nt
    buffer_load_dwordx4 a[100:103], v11, s[12:15], s28 offen offset:320 nt
    s_branch Lsr4
Ldisp3_1:
    s_cmp_lg_u32 s25, 2
    s_cbranch_scc1 Ldisp3_2
    buffer_load_dwordx4 a[104:107], v11, s[12:15], s29 offen offset:256 nt
    buffer_load_dwordx4 a[108:111], v11, s[12:15], s29 offen offset:320 nt
    s_branch Lsr4
Ldisp3_2:
    s_cmp_lg_u32 s25, 3
    s_cbranch_scc1 Ldisp3_3
    buffer_load_dwordx4 a[112:115], v11, s[12:15], s30 offen offset:256 nt
    buffer_load_dwordx4 a[116:119], v11, s[12:15], s30 offen offset:320 nt
    s_branch Lsr4
Ldisp3_3:
    buffer_load_dwordx4 a[120:123], v11, s[12:15], s31 offen offset:256 nt
    buffer_load_dwordx4 a[124:127], v11, s[12:15], s31 offen offset:320 nt
    s_branch Lsr4
.fill 256, 4, 0xbf800000
Lhot_end:
Lrs1:
    s_call_b64 s[32:33], Lfix_1
    s_branch Lrr2
Lrs5:
    s_call_b64 s[32:33], Lfix_0
    s_branch Lrr6
Lrs7:
    s_call_b64 s[32:33], Lfix_1
    s_branch Lrr8
Lrs9:
    s_call_b64 s[32:33], Lfix_1
    s_branch Lrr10
Lrs11:
    s_call_b64 s[32:33], Lfix_0
    s_branch Lrr12
Lrs13:
    s_call_b64 s[32:33], Lfix_1
    s_branch Lrr14
Lrs15:
    s_call_b64 s[32:33], Lfix_0
    s_branch Lrr16
Lrs17:
    s_call_b64 s[32:33], Lfix31_0
    s_branch Lrr18
Lrs19:
    s_call_b64 s[32:33], Lfix31_1
    s_branch Lrr20
Lrs21:
    s_call_b64 s[32:33], Lfix31_2
    s_branch Lrr22
Lrs23:
    s_call_b64 s[32:33], Lfix31_3
    s_branch Lrr24
Lfix_1:
    s_nop 7
    v_max3_f32 v30, v96, v97, v98
    v_max3_f32 v30, v30, v99, v100
    v_max3_f32 v30, v30, v101, v102
    v_max_f32 v30, v30, v103
    v_mov_b32 v31, v30
    s_nop 1
    v_permlane32_swap_b32 v31, v30
    v_max_f32 v30, v30, v31
    v_mov_b32 v31, v30
    s_nop 1
    v_permlane16_swap_b32 v31, v30
    v_max_f32 v30, v30, v31
    v_max_f32 v30, 0, v30
    v_sub_f32 v96, v96, v30
    v_sub_f32 v97, v97, v30
    v_sub_f32 v98, v98, v30
    v_sub_f32 v99, v99, v30
    v_sub_f32 v100, v100, v30
    v_sub_f32 v101, v101, v30
    v_sub_f32 v102, v102, v30
    v_sub_f32 v103, v103, v30
    v_add_f32 v18, v18, v30
    v_exp_f32 v39, -v30
    s_nop 0
    v_mul_f32 v22, v22, v39
    v_mul_f32 v128, v128, v39
    v_mul_f32 v129, v129, v39
    v_mul_f32 v130, v130, v39
    v_mul_f32 v131, v131, v39
    v_mul_f32 v144, v144, v39
    v_mul_f32 v145, v145, v39
    v_mul_f32 v146, v146, v39
    v_mul_f32 v147, v147, v39
    v_mul_f32 v160, v160, v39
    v_mul_f32 v161, v161, v39
    v_mul_f32 v162, v162, v39
    v_mul_f32 v163, v163, v39
    v_mul_f32 v176, v176, v39
    v_mul_f32 v177, v177, v39
    v_mul_f32 v178, v178, v39
    v_mul_f32 v179, v179, v39
    v_mul_f32 v192, v192, v39
    v_mul_f32 v193, v193, v39
    v_mul_f32 v194, v194, v39
    v_mul_f32 v195, v195, v39
    v_mul_f32 v208, v208, v39
    v_mul_f32 v209, v209, v39
    v_mul_f32 v210, v210, v39
    v_mul_f32 v211, v211, v39
    v_mul_f32 v224, v224, v39
    v_mul_f32 v225, v225, v39
    v_mul_f32 v226, v226, v39
    v_mul_f32 v227, v227, v39
    v_mul_f32 v240, v240, v39
    v_mul_f32 v241, v241, v39
    v_mul_f32 v242, v242, v39
    v_mul_f32 v243, v243, v39
    v_accvgpr_read_b32 v30, a152
    v_accvgpr_read_b32 v31, a153
    v_accvgpr_read_b32 v32, a154
    v_accvgpr_read_b32 v33, a155
    v_mul_f32 v30, v30, v39
    v_mul_f32 v31, v31, v39
    v_mul_f32 v32, v32, v39
    v_mul_f32 v33, v33, v39
    v_accvgpr_write_b32 a152, v30
    v_accvgpr_write_b32 a153, v31
    v_accvgpr_write_b32 a154, v32
    v_accvgpr_write_b32 a155, v33
    v_accvgpr_read_b32 v30, a168
    v_accvgpr_read_b32 v31, a169
    v_accvgpr_read_b32 v32, a170
    v_accvgpr_read_b32 v33, a171
    v_mul_f32 v30, v30, v39
    v_mul_f32 v31, v31, v39
    v_mul_f32 v32, v32, v39
    v_mul_f32 v33, v33, v39
    v_accvgpr_write_b32 a168, v30
    v_accvgpr_write_b32 a169, v31
    v_accvgpr_write_b32 a170, v32
    v_accvgpr_write_b32 a171, v33
    v_accvgpr_read_b32 v30, a184
    v_accvgpr_read_b32 v31, a185
    v_accvgpr_read_b32 v32, a186
    v_accvgpr_read_b32 v33, a187
    v_mul_f32 v30, v30, v39
    v_mul_f32 v31, v31, v39
    v_mul_f32 v32, v32, v39
    v_mul_f32 v33, v33, v39
    v_accvgpr_write_b32 a184, v30
    v_accvgpr_write_b32 a185, v31
    v_accvgpr_write_b32 a186, v32
    v_accvgpr_write_b32 a187, v33
    v_accvgpr_read_b32 v30, a200
    v_accvgpr_read_b32 v31, a201
    v_accvgpr_read_b32 v32, a202
    v_accvgpr_read_b32 v33, a203
    v_mul_f32 v30, v30, v39
    v_mul_f32 v31, v31, v39
    v_mul_f32 v32, v32, v39
    v_mul_f32 v33, v33, v39
    v_accvgpr_write_b32 a200, v30
    v_accvgpr_write_b32 a201, v31
    v_accvgpr_write_b32 a202, v32
    v_accvgpr_write_b32 a203, v33
    v_exp_f32 v30, v96
    s_nop 0
    v_exp_f32 v31, v97
    s_nop 0
    v_exp_f32 v32, v98
    s_nop 0
    v_add_f32 v26, v30, v31
    v_cvt_pk_bf16_f32 v48, v30, v31
    v_exp_f32 v33, v99
    s_nop 0
    v_add_f32 v26, v26, v32
    v_exp_f32 v30, v100
    s_nop 0
    v_add_f32 v26, v26, v33
    v_cvt_pk_bf16_f32 v49, v32, v33
    v_exp_f32 v31, v101
    s_nop 0
    v_add_f32 v26, v26, v30
    v_exp_f32 v32, v102
    s_nop 0
    v_add_f32 v26, v26, v31
    v_cvt_pk_bf16_f32 v50, v30, v31
    v_exp_f32 v33, v103
    s_nop 0
    v_add_f32 v26, v26, v32
    v_add_f32 v26, v26, v33
    v_cvt_pk_bf16_f32 v51, v32, v33
    v_max3_f32 v30, v104, v105, v106
    v_max3_f32 v30, v30, v107, v108
    v_max3_f32 v30, v30, v109, v110
    v_max_f32 v30, v30, v111
    v_mov_b32 v31, v30
    s_nop 1
    v_permlane32_swap_b32 v31, v30
    v_max_f32 v30, v30, v31
    v_mov_b32 v31, v30
    s_nop 1
    v_permlane16_swap_b32 v31, v30
    v_max_f32 v30, v30, v31
    v_max_f32 v30, 0, v30
    v_sub_f32 v104, v104, v30
    v_sub_f32 v105, v105, v30
    v_sub_f32 v106, v106, v30
    v_sub_f32 v107, v107, v30
    v_sub_f32 v108, v108, v30
    v_sub_f32 v109, v109, v30
    v_sub_f32 v110, v110, v30
    v_sub_f32 v111, v111, v30
    v_add_f32 v19, v19, v30
    v_exp_f32 v39, -v30
    s_nop 0
    v_mul_f32 v23, v23, v39
    v_mul_f32 v132, v132, v39
    v_mul_f32 v133, v133, v39
    v_mul_f32 v134, v134, v39
    v_mul_f32 v135, v135, v39
    v_mul_f32 v148, v148, v39
    v_mul_f32 v149, v149, v39
    v_mul_f32 v150, v150, v39
    v_mul_f32 v151, v151, v39
    v_mul_f32 v164, v164, v39
    v_mul_f32 v165, v165, v39
    v_mul_f32 v166, v166, v39
    v_mul_f32 v167, v167, v39
    v_mul_f32 v180, v180, v39
    v_mul_f32 v181, v181, v39
    v_mul_f32 v182, v182, v39
    v_mul_f32 v183, v183, v39
    v_mul_f32 v196, v196, v39
    v_mul_f32 v197, v197, v39
    v_mul_f32 v198, v198, v39
    v_mul_f32 v199, v199, v39
    v_mul_f32 v212, v212, v39
    v_mul_f32 v213, v213, v39
    v_mul_f32 v214, v214, v39
    v_mul_f32 v215, v215, v39
    v_mul_f32 v228, v228, v39
    v_mul_f32 v229, v229, v39
    v_mul_f32 v230, v230, v39
    v_mul_f32 v231, v231, v39
    v_mul_f32 v244, v244, v39
    v_mul_f32 v245, v245, v39
    v_mul_f32 v246, v246, v39
    v_mul_f32 v247, v247, v39
    v_accvgpr_read_b32 v30, a156
    v_accvgpr_read_b32 v31, a157
    v_accvgpr_read_b32 v32, a158
    v_accvgpr_read_b32 v33, a159
    v_mul_f32 v30, v30, v39
    v_mul_f32 v31, v31, v39
    v_mul_f32 v32, v32, v39
    v_mul_f32 v33, v33, v39
    v_accvgpr_write_b32 a156, v30
    v_accvgpr_write_b32 a157, v31
    v_accvgpr_write_b32 a158, v32
    v_accvgpr_write_b32 a159, v33
    v_accvgpr_read_b32 v30, a172
    v_accvgpr_read_b32 v31, a173
    v_accvgpr_read_b32 v32, a174
    v_accvgpr_read_b32 v33, a175
    v_mul_f32 v30, v30, v39
    v_mul_f32 v31, v31, v39
    v_mul_f32 v32, v32, v39
    v_mul_f32 v33, v33, v39
    v_accvgpr_write_b32 a172, v30
    v_accvgpr_write_b32 a173, v31
    v_accvgpr_write_b32 a174, v32
    v_accvgpr_write_b32 a175, v33
    v_accvgpr_read_b32 v30, a188
    v_accvgpr_read_b32 v31, a189
    v_accvgpr_read_b32 v32, a190
    v_accvgpr_read_b32 v33, a191
    v_mul_f32 v30, v30, v39
    v_mul_f32 v31, v31, v39
    v_mul_f32 v32, v32, v39
    v_mul_f32 v33, v33, v39
    v_accvgpr_write_b32 a188, v30
    v_accvgpr_write_b32 a189, v31
    v_accvgpr_write_b32 a190, v32
    v_accvgpr_write_b32 a191, v33
    v_accvgpr_read_b32 v30, a204
    v_accvgpr_read_b32 v31, a205
    v_accvgpr_read_b32 v32, a206
    v_accvgpr_read_b32 v33, a207
    v_mul_f32 v30, v30, v39
    v_mul_f32 v31, v31, v39
    v_mul_f32 v32, v32, v39
    v_mul_f32 v33, v33, v39
    v_accvgpr_write_b32 a204, v30
    v_accvgpr_write_b32 a205, v31
    v_accvgpr_write_b32 a206, v32
    v_accvgpr_write_b32 a207, v33
    v_exp_f32 v30, v104
    s_nop 0
    v_exp_f32 v31, v105
    s_nop 0
    v_exp_f32 v32, v106
    s_nop 0
    v_add_f32 v27, v30, v31
    v_cvt_pk_bf16_f32 v52, v30, v31
    v_exp_f32 v33, v107
    s_nop 0
    v_add_f32 v27, v27, v32
    v_exp_f32 v30, v108
    s_nop 0
    v_add_f32 v27, v27, v33
    v_cvt_pk_bf16_f32 v53, v32, v33
    v_exp_f32 v31, v109
    s_nop 0
    v_add_f32 v27, v27, v30
    v_exp_f32 v32, v110
    s_nop 0
    v_add_f32 v27, v27, v31
    v_cvt_pk_bf16_f32 v54, v30, v31
    v_exp_f32 v33, v111
    s_nop 0
    v_add_f32 v27, v27, v32
    v_add_f32 v27, v27, v33
    v_cvt_pk_bf16_f32 v55, v32, v33
    v_max3_f32 v30, v112, v113, v114
    v_max3_f32 v30, v30, v115, v116
    v_max3_f32 v30, v30, v117, v118
    v_max_f32 v30, v30, v119
    v_mov_b32 v31, v30
    s_nop 1
    v_permlane32_swap_b32 v31, v30
    v_max_f32 v30, v30, v31
    v_mov_b32 v31, v30
    s_nop 1
    v_permlane16_swap_b32 v31, v30
    v_max_f32 v30, v30, v31
    v_max_f32 v30, 0, v30
    v_sub_f32 v112, v112, v30
    v_sub_f32 v113, v113, v30
    v_sub_f32 v114, v114, v30
    v_sub_f32 v115, v115, v30
    v_sub_f32 v116, v116, v30
    v_sub_f32 v117, v117, v30
    v_sub_f32 v118, v118, v30
    v_sub_f32 v119, v119, v30
    v_add_f32 v20, v20, v30
    v_exp_f32 v39, -v30
    s_nop 0
    v_mul_f32 v24, v24, v39
    v_mul_f32 v136, v136, v39
    v_mul_f32 v137, v137, v39
    v_mul_f32 v138, v138, v39
    v_mul_f32 v139, v139, v39
    v_mul_f32 v152, v152, v39
    v_mul_f32 v153, v153, v39
    v_mul_f32 v154, v154, v39
    v_mul_f32 v155, v155, v39
    v_mul_f32 v168, v168, v39
    v_mul_f32 v169, v169, v39
    v_mul_f32 v170, v170, v39
    v_mul_f32 v171, v171, v39
    v_mul_f32 v184, v184, v39
    v_mul_f32 v185, v185, v39
    v_mul_f32 v186, v186, v39
    v_mul_f32 v187, v187, v39
    v_mul_f32 v200, v200, v39
    v_mul_f32 v201, v201, v39
    v_mul_f32 v202, v202, v39
    v_mul_f32 v203, v203, v39
    v_mul_f32 v216, v216, v39
    v_mul_f32 v217, v217, v39
    v_mul_f32 v218, v218, v39
    v_mul_f32 v219, v219, v39
    v_mul_f32 v232, v232, v39
    v_mul_f32 v233, v233, v39
    v_mul_f32 v234, v234, v39
    v_mul_f32 v235, v235, v39
    v_mul_f32 v248, v248, v39
    v_mul_f32 v249, v249, v39
    v_mul_f32 v250, v250, v39
    v_mul_f32 v251, v251, v39
    v_accvgpr_read_b32 v30, a160
    v_accvgpr_read_b32 v31, a161
    v_accvgpr_read_b32 v32, a162
    v_accvgpr_read_b32 v33, a163
    v_mul_f32 v30, v30, v39
    v_mul_f32 v31, v31, v39
    v_mul_f32 v32, v32, v39
    v_mul_f32 v33, v33, v39
    v_accvgpr_write_b32 a160, v30
    v_accvgpr_write_b32 a161, v31
    v_accvgpr_write_b32 a162, v32
    v_accvgpr_write_b32 a163, v33
    v_accvgpr_read_b32 v30, a176
    v_accvgpr_read_b32 v31, a177
    v_accvgpr_read_b32 v32, a178
    v_accvgpr_read_b32 v33, a179
    v_mul_f32 v30, v30, v39
    v_mul_f32 v31, v31, v39
    v_mul_f32 v32, v32, v39
    v_mul_f32 v33, v33, v39
    v_accvgpr_write_b32 a176, v30
    v_accvgpr_write_b32 a177, v31
    v_accvgpr_write_b32 a178, v32
    v_accvgpr_write_b32 a179, v33
    v_accvgpr_read_b32 v30, a192
    v_accvgpr_read_b32 v31, a193
    v_accvgpr_read_b32 v32, a194
    v_accvgpr_read_b32 v33, a195
    v_mul_f32 v30, v30, v39
    v_mul_f32 v31, v31, v39
    v_mul_f32 v32, v32, v39
    v_mul_f32 v33, v33, v39
    v_accvgpr_write_b32 a192, v30
    v_accvgpr_write_b32 a193, v31
    v_accvgpr_write_b32 a194, v32
    v_accvgpr_write_b32 a195, v33
    v_accvgpr_read_b32 v30, a208
    v_accvgpr_read_b32 v31, a209
    v_accvgpr_read_b32 v32, a210
    v_accvgpr_read_b32 v33, a211
    v_mul_f32 v30, v30, v39
    v_mul_f32 v31, v31, v39
    v_mul_f32 v32, v32, v39
    v_mul_f32 v33, v33, v39
    v_accvgpr_write_b32 a208, v30
    v_accvgpr_write_b32 a209, v31
    v_accvgpr_write_b32 a210, v32
    v_accvgpr_write_b32 a211, v33
    v_exp_f32 v30, v112
    s_nop 0
    v_exp_f32 v31, v113
    s_nop 0
    v_exp_f32 v32, v114
    s_nop 0
    v_add_f32 v28, v30, v31
    v_cvt_pk_bf16_f32 v56, v30, v31
    v_exp_f32 v33, v115
    s_nop 0
    v_add_f32 v28, v28, v32
    v_exp_f32 v30, v116
    s_nop 0
    v_add_f32 v28, v28, v33
    v_cvt_pk_bf16_f32 v57, v32, v33
    v_exp_f32 v31, v117
    s_nop 0
    v_add_f32 v28, v28, v30
    v_exp_f32 v32, v118
    s_nop 0
    v_add_f32 v28, v28, v31
    v_cvt_pk_bf16_f32 v58, v30, v31
    v_exp_f32 v33, v119
    s_nop 0
    v_add_f32 v28, v28, v32
    v_add_f32 v28, v28, v33
    v_cvt_pk_bf16_f32 v59, v32, v33
    v_max3_f32 v30, v120, v121, v122
    v_max3_f32 v30, v30, v123, v124
    v_max3_f32 v30, v30, v125, v126
    v_max_f32 v30, v30, v127
    v_mov_b32 v31, v30
    s_nop 1
    v_permlane32_swap_b32 v31, v30
    v_max_f32 v30, v30, v31
    v_mov_b32 v31, v30
    s_nop 1
    v_permlane16_swap_b32 v31, v30
    v_max_f32 v30, v30, v31
    v_max_f32 v30, 0, v30
    v_sub_f32 v120, v120, v30
    v_sub_f32 v121, v121, v30
    v_sub_f32 v122, v122, v30
    v_sub_f32 v123, v123, v30
    v_sub_f32 v124, v124, v30
    v_sub_f32 v125, v125, v30
    v_sub_f32 v126, v126, v30
    v_sub_f32 v127, v127, v30
    v_add_f32 v21, v21, v30
    v_exp_f32 v39, -v30
    s_nop 0
    v_mul_f32 v25, v25, v39
    v_mul_f32 v140, v140, v39
    v_mul_f32 v141, v141, v39
    v_mul_f32 v142, v142, v39
    v_mul_f32 v143, v143, v39
    v_mul_f32 v156, v156, v39
    v_mul_f32 v157, v157, v39
    v_mul_f32 v158, v158, v39
    v_mul_f32 v159, v159, v39
    v_mul_f32 v172, v172, v39
    v_mul_f32 v173, v173, v39
    v_mul_f32 v174, v174, v39
    v_mul_f32 v175, v175, v39
    v_mul_f32 v188, v188, v39
    v_mul_f32 v189, v189, v39
    v_mul_f32 v190, v190, v39
    v_mul_f32 v191, v191, v39
    v_mul_f32 v204, v204, v39
    v_mul_f32 v205, v205, v39
    v_mul_f32 v206, v206, v39
    v_mul_f32 v207, v207, v39
    v_mul_f32 v220, v220, v39
    v_mul_f32 v221, v221, v39
    v_mul_f32 v222, v222, v39
    v_mul_f32 v223, v223, v39
    v_mul_f32 v236, v236, v39
    v_mul_f32 v237, v237, v39
    v_mul_f32 v238, v238, v39
    v_mul_f32 v239, v239, v39
    v_mul_f32 v252, v252, v39
    v_mul_f32 v253, v253, v39
    v_mul_f32 v254, v254, v39
    v_mul_f32 v255, v255, v39
    v_accvgpr_read_b32 v30, a164
    v_accvgpr_read_b32 v31, a165
    v_accvgpr_read_b32 v32, a166
    v_accvgpr_read_b32 v33, a167
    v_mul_f32 v30, v30, v39
    v_mul_f32 v31, v31, v39
    v_mul_f32 v32, v32, v39
    v_mul_f32 v33, v33, v39
    v_accvgpr_write_b32 a164, v30
    v_accvgpr_write_b32 a165, v31
    v_accvgpr_write_b32 a166, v32
    v_accvgpr_write_b32 a167, v33
    v_accvgpr_read_b32 v30, a180
    v_accvgpr_read_b32 v31, a181
    v_accvgpr_read_b32 v32, a182
    v_accvgpr_read_b32 v33, a183
    v_mul_f32 v30, v30, v39
    v_mul_f32 v31, v31, v39
    v_mul_f32 v32, v32, v39
    v_mul_f32 v33, v33, v39
    v_accvgpr_write_b32 a180, v30
    v_accvgpr_write_b32 a181, v31
    v_accvgpr_write_b32 a182, v32
    v_accvgpr_write_b32 a183, v33
    v_accvgpr_read_b32 v30, a196
    v_accvgpr_read_b32 v31, a197
    v_accvgpr_read_b32 v32, a198
    v_accvgpr_read_b32 v33, a199
    v_mul_f32 v30, v30, v39
    v_mul_f32 v31, v31, v39
    v_mul_f32 v32, v32, v39
    v_mul_f32 v33, v33, v39
    v_accvgpr_write_b32 a196, v30
    v_accvgpr_write_b32 a197, v31
    v_accvgpr_write_b32 a198, v32
    v_accvgpr_write_b32 a199, v33
    v_accvgpr_read_b32 v30, a212
    v_accvgpr_read_b32 v31, a213
    v_accvgpr_read_b32 v32, a214
    v_accvgpr_read_b32 v33, a215
    v_mul_f32 v30, v30, v39
    v_mul_f32 v31, v31, v39
    v_mul_f32 v32, v32, v39
    v_mul_f32 v33, v33, v39
    v_accvgpr_write_b32 a212, v30
    v_accvgpr_write_b32 a213, v31
    v_accvgpr_write_b32 a214, v32
    v_accvgpr_write_b32 a215, v33
    v_exp_f32 v30, v120
    s_nop 0
    v_exp_f32 v31, v121
    s_nop 0
    v_exp_f32 v32, v122
    s_nop 0
    v_add_f32 v29, v30, v31
    v_cvt_pk_bf16_f32 v60, v30, v31
    v_exp_f32 v33, v123
    s_nop 0
    v_add_f32 v29, v29, v32
    v_exp_f32 v30, v124
    s_nop 0
    v_add_f32 v29, v29, v33
    v_cvt_pk_bf16_f32 v61, v32, v33
    v_exp_f32 v31, v125
    s_nop 0
    v_add_f32 v29, v29, v30
    v_exp_f32 v32, v126
    s_nop 0
    v_add_f32 v29, v29, v31
    v_cvt_pk_bf16_f32 v62, v30, v31
    v_exp_f32 v33, v127
    s_nop 0
    v_add_f32 v29, v29, v32
    v_add_f32 v29, v29, v33
    v_cvt_pk_bf16_f32 v63, v32, v33
    s_nop 1
    s_setpc_b64 s[32:33]
Lfix_0:
    s_nop 7
    v_max3_f32 v30, v64, v65, v66
    v_max3_f32 v30, v30, v67, v68
    v_max3_f32 v30, v30, v69, v70
    v_max_f32 v30, v30, v71
    v_mov_b32 v31, v30
    s_nop 1
    v_permlane32_swap_b32 v31, v30
    v_max_f32 v30, v30, v31
    v_mov_b32 v31, v30
    s_nop 1
    v_permlane16_swap_b32 v31, v30
    v_max_f32 v30, v30, v31
    v_max_f32 v30, 0, v30
    v_sub_f32 v64, v64, v30
    v_sub_f32 v65, v65, v30
    v_sub_f32 v66, v66, v30
    v_sub_f32 v67, v67, v30
    v_sub_f32 v68, v68, v30
    v_sub_f32 v69, v69, v30
    v_sub_f32 v70, v70, v30
    v_sub_f32 v71, v71, v30
    v_add_f32 v18, v18, v30
    v_exp_f32 v39, -v30
    s_nop 0
    v_mul_f32 v22, v22, v39
    v_mul_f32 v128, v128, v39
    v_mul_f32 v129, v129, v39
    v_mul_f32 v130, v130, v39
    v_mul_f32 v131, v131, v39
    v_mul_f32 v144, v144, v39
    v_mul_f32 v145, v145, v39
    v_mul_f32 v146, v146, v39
    v_mul_f32 v147, v147, v39
    v_mul_f32 v160, v160, v39
    v_mul_f32 v161, v161, v39
    v_mul_f32 v162, v162, v39
    v_mul_f32 v163, v163, v39
    v_mul_f32 v176, v176, v39
    v_mul_f32 v177, v177, v39
    v_mul_f32 v178, v178, v39
    v_mul_f32 v179, v179, v39
    v_mul_f32 v192, v192, v39
    v_mul_f32 v193, v193, v39
    v_mul_f32 v194, v194, v39
    v_mul_f32 v195, v195, v39
    v_mul_f32 v208, v208, v39
    v_mul_f32 v209, v209, v39
    v_mul_f32 v210, v210, v39
    v_mul_f32 v211, v211, v39
    v_mul_f32 v224, v224, v39
    v_mul_f32 v225, v225, v39
    v_mul_f32 v226, v226, v39
    v_mul_f32 v227, v227, v39
    v_mul_f32 v240, v240, v39
    v_mul_f32 v241, v241, v39
    v_mul_f32 v242, v242, v39
    v_mul_f32 v243, v243, v39
    v_accvgpr_read_b32 v30, a152
    v_accvgpr_read_b32 v31, a153
    v_accvgpr_read_b32 v32, a154
    v_accvgpr_read_b32 v33, a155
    v_mul_f32 v30, v30, v39
    v_mul_f32 v31, v31, v39
    v_mul_f32 v32, v32, v39
    v_mul_f32 v33, v33, v39
    v_accvgpr_write_b32 a152, v30
    v_accvgpr_write_b32 a153, v31
    v_accvgpr_write_b32 a154, v32
    v_accvgpr_write_b32 a155, v33
    v_accvgpr_read_b32 v30, a168
    v_accvgpr_read_b32 v31, a169
    v_accvgpr_read_b32 v32, a170
    v_accvgpr_read_b32 v33, a171
    v_mul_f32 v30, v30, v39
    v_mul_f32 v31, v31, v39
    v_mul_f32 v32, v32, v39
    v_mul_f32 v33, v33, v39
    v_accvgpr_write_b32 a168, v30
    v_accvgpr_write_b32 a169, v31
    v_accvgpr_write_b32 a170, v32
    v_accvgpr_write_b32 a171, v33
    v_accvgpr_read_b32 v30, a184
    v_accvgpr_read_b32 v31, a185
    v_accvgpr_read_b32 v32, a186
    v_accvgpr_read_b32 v33, a187
    v_mul_f32 v30, v30, v39
    v_mul_f32 v31, v31, v39
    v_mul_f32 v32, v32, v39
    v_mul_f32 v33, v33, v39
    v_accvgpr_write_b32 a184, v30
    v_accvgpr_write_b32 a185, v31
    v_accvgpr_write_b32 a186, v32
    v_accvgpr_write_b32 a187, v33
    v_accvgpr_read_b32 v30, a200
    v_accvgpr_read_b32 v31, a201
    v_accvgpr_read_b32 v32, a202
    v_accvgpr_read_b32 v33, a203
    v_mul_f32 v30, v30, v39
    v_mul_f32 v31, v31, v39
    v_mul_f32 v32, v32, v39
    v_mul_f32 v33, v33, v39
    v_accvgpr_write_b32 a200, v30
    v_accvgpr_write_b32 a201, v31
    v_accvgpr_write_b32 a202, v32
    v_accvgpr_write_b32 a203, v33
    v_exp_f32 v30, v64
    s_nop 0
    v_exp_f32 v31, v65
    s_nop 0
    v_exp_f32 v32, v66
    s_nop 0
    v_add_f32 v26, v30, v31
    v_cvt_pk_bf16_f32 v40, v30, v31
    v_exp_f32 v33, v67
    s_nop 0
    v_add_f32 v26, v26, v32
    v_exp_f32 v30, v68
    s_nop 0
    v_add_f32 v26, v26, v33
    v_cvt_pk_bf16_f32 v41, v32, v33
    v_exp_f32 v31, v69
    s_nop 0
    v_add_f32 v26, v26, v30
    v_exp_f32 v32, v70
    s_nop 0
    v_add_f32 v26, v26, v31
    v_cvt_pk_bf16_f32 v42, v30, v31
    v_exp_f32 v33, v71
    s_nop 0
    v_add_f32 v26, v26, v32
    v_add_f32 v26, v26, v33
    v_cvt_pk_bf16_f32 v43, v32, v33
    v_max3_f32 v30, v72, v73, v74
    v_max3_f32 v30, v30, v75, v76
    v_max3_f32 v30, v30, v77, v78
    v_max_f32 v30, v30, v79
    v_mov_b32 v31, v30
    s_nop 1
    v_permlane32_swap_b32 v31, v30
    v_max_f32 v30, v30, v31
    v_mov_b32 v31, v30
    s_nop 1
    v_permlane16_swap_b32 v31, v30
    v_max_f32 v30, v30, v31
    v_max_f32 v30, 0, v30
    v_sub_f32 v72, v72, v30
    v_sub_f32 v73, v73, v30
    v_sub_f32 v74, v74, v30
    v_sub_f32 v75, v75, v30
    v_sub_f32 v76, v76, v30
    v_sub_f32 v77, v77, v30
    v_sub_f32 v78, v78, v30
    v_sub_f32 v79, v79, v30
    v_add_f32 v19, v19, v30
    v_exp_f32 v39, -v30
    s_nop 0
    v_mul_f32 v23, v23, v39
    v_mul_f32 v132, v132, v39
    v_mul_f32 v133, v133, v39
    v_mul_f32 v134, v134, v39
    v_mul_f32 v135, v135, v39
    v_mul_f32 v148, v148, v39
    v_mul_f32 v149, v149, v39
    v_mul_f32 v150, v150, v39
    v_mul_f32 v151, v151, v39
    v_mul_f32 v164, v164, v39
    v_mul_f32 v165, v165, v39
    v_mul_f32 v166, v166, v39
    v_mul_f32 v167, v167, v39
    v_mul_f32 v180, v180, v39
    v_mul_f32 v181, v181, v39
    v_mul_f32 v182, v182, v39
    v_mul_f32 v183, v183, v39
    v_mul_f32 v196, v196, v39
    v_mul_f32 v197, v197, v39
    v_mul_f32 v198, v198, v39
    v_mul_f32 v199, v199, v39
    v_mul_f32 v212, v212, v39
    v_mul_f32 v213, v213, v39
    v_mul_f32 v214, v214, v39
    v_mul_f32 v215, v215, v39
    v_mul_f32 v228, v228, v39
    v_mul_f32 v229, v229, v39
    v_mul_f32 v230, v230, v39
    v_mul_f32 v231, v231, v39
    v_mul_f32 v244, v244, v39
    v_mul_f32 v245, v245, v39
    v_mul_f32 v246, v246, v39
    v_mul_f32 v247, v247, v39
    v_accvgpr_read_b32 v30, a156
    v_accvgpr_read_b32 v31, a157
    v_accvgpr_read_b32 v32, a158
    v_accvgpr_read_b32 v33, a159
    v_mul_f32 v30, v30, v39
    v_mul_f32 v31, v31, v39
    v_mul_f32 v32, v32, v39
    v_mul_f32 v33, v33, v39
    v_accvgpr_write_b32 a156, v30
    v_accvgpr_write_b32 a157, v31
    v_accvgpr_write_b32 a158, v32
    v_accvgpr_write_b32 a159, v33
    v_accvgpr_read_b32 v30, a172
    v_accvgpr_read_b32 v31, a173
    v_accvgpr_read_b32 v32, a174
    v_accvgpr_read_b32 v33, a175
    v_mul_f32 v30, v30, v39
    v_mul_f32 v31, v31, v39
    v_mul_f32 v32, v32, v39
    v_mul_f32 v33, v33, v39
    v_accvgpr_write_b32 a172, v30
    v_accvgpr_write_b32 a173, v31
    v_accvgpr_write_b32 a174, v32
    v_accvgpr_write_b32 a175, v33
    v_accvgpr_read_b32 v30, a188
    v_accvgpr_read_b32 v31, a189
    v_accvgpr_read_b32 v32, a190
    v_accvgpr_read_b32 v33, a191
    v_mul_f32 v30, v30, v39
    v_mul_f32 v31, v31, v39
    v_mul_f32 v32, v32, v39
    v_mul_f32 v33, v33, v39
    v_accvgpr_write_b32 a188, v30
    v_accvgpr_write_b32 a189, v31
    v_accvgpr_write_b32 a190, v32
    v_accvgpr_write_b32 a191, v33
    v_accvgpr_read_b32 v30, a204
    v_accvgpr_read_b32 v31, a205
    v_accvgpr_read_b32 v32, a206
    v_accvgpr_read_b32 v33, a207
    v_mul_f32 v30, v30, v39
    v_mul_f32 v31, v31, v39
    v_mul_f32 v32, v32, v39
    v_mul_f32 v33, v33, v39
    v_accvgpr_write_b32 a204, v30
    v_accvgpr_write_b32 a205, v31
    v_accvgpr_write_b32 a206, v32
    v_accvgpr_write_b32 a207, v33
    v_exp_f32 v30, v72
    s_nop 0
    v_exp_f32 v31, v73
    s_nop 0
    v_exp_f32 v32, v74
    s_nop 0
    v_add_f32 v27, v30, v31
    v_cvt_pk_bf16_f32 v44, v30, v31
    v_exp_f32 v33, v75
    s_nop 0
    v_add_f32 v27, v27, v32
    v_exp_f32 v30, v76
    s_nop 0
    v_add_f32 v27, v27, v33
    v_cvt_pk_bf16_f32 v45, v32, v33
    v_exp_f32 v31, v77
    s_nop 0
    v_add_f32 v27, v27, v30
    v_exp_f32 v32, v78
    s_nop 0
    v_add_f32 v27, v27, v31
    v_cvt_pk_bf16_f32 v46, v30, v31
    v_exp_f32 v33, v79
    s_nop 0
    v_add_f32 v27, v27, v32
    v_add_f32 v27, v27, v33
    v_cvt_pk_bf16_f32 v47, v32, v33
    v_max3_f32 v30, v80, v81, v82
    v_max3_f32 v30, v30, v83, v84
    v_max3_f32 v30, v30, v85, v86
    v_max_f32 v30, v30, v87
    v_mov_b32 v31, v30
    s_nop 1
    v_permlane32_swap_b32 v31, v30
    v_max_f32 v30, v30, v31
    v_mov_b32 v31, v30
    s_nop 1
    v_permlane16_swap_b32 v31, v30
    v_max_f32 v30, v30, v31
    v_max_f32 v30, 0, v30
    v_sub_f32 v80, v80, v30
    v_sub_f32 v81, v81, v30
    v_sub_f32 v82, v82, v30
    v_sub_f32 v83, v83, v30
    v_sub_f32 v84, v84, v30
    v_sub_f32 v85, v85, v30
    v_sub_f32 v86, v86, v30
    v_sub_f32 v87, v87, v30
    v_add_f32 v20, v20, v30
    v_exp_f32 v39, -v30
    s_nop 0
    v_mul_f32 v24, v24, v39
    v_mul_f32 v136, v136, v39
    v_mul_f32 v137, v137, v39
    v_mul_f32 v138, v138, v39
    v_mul_f32 v139, v139, v39
    v_mul_f32 v152, v152, v39
    v_mul_f32 v153, v153, v39
    v_mul_f32 v154, v154, v39
    v_mul_f32 v155, v155, v39
    v_mul_f32 v168, v168, v39
    v_mul_f32 v169, v169, v39
    v_mul_f32 v170, v170, v39
    v_mul_f32 v171, v171, v39
    v_mul_f32 v184, v184, v39
    v_mul_f32 v185, v185, v39
    v_mul_f32 v186, v186, v39
    v_mul_f32 v187, v187, v39
    v_mul_f32 v200, v200, v39
    v_mul_f32 v201, v201, v39
    v_mul_f32 v202, v202, v39
    v_mul_f32 v203, v203, v39
    v_mul_f32 v216, v216, v39
    v_mul_f32 v217, v217, v39
    v_mul_f32 v218, v218, v39
    v_mul_f32 v219, v219, v39
    v_mul_f32 v232, v232, v39
    v_mul_f32 v233, v233, v39
    v_mul_f32 v234, v234, v39
    v_mul_f32 v235, v235, v39
    v_mul_f32 v248, v248, v39
    v_mul_f32 v249, v249, v39
    v_mul_f32 v250, v250, v39
    v_mul_f32 v251, v251, v39
    v_accvgpr_read_b32 v30, a160
    v_accvgpr_read_b32 v31, a161
    v_accvgpr_read_b32 v32, a162
    v_accvgpr_read_b32 v33, a163
    v_mul_f32 v30, v30, v39
    v_mul_f32 v31, v31, v39
    v_mul_f32 v32, v32, v39
    v_mul_f32 v33, v33, v39
    v_accvgpr_write_b32 a160, v30
    v_accvgpr_write_b32 a161, v31
    v_accvgpr_write_b32 a162, v32
    v_accvgpr_write_b32 a163, v33
    v_accvgpr_read_b32 v30, a176
    v_accvgpr_read_b32 v31, a177
    v_accvgpr_read_b32 v32, a178
    v_accvgpr_read_b32 v33, a179
    v_mul_f32 v30, v30, v39
    v_mul_f32 v31, v31, v39
    v_mul_f32 v32, v32, v39
    v_mul_f32 v33, v33, v39
    v_accvgpr_write_b32 a176, v30
    v_accvgpr_write_b32 a177, v31
    v_accvgpr_write_b32 a178, v32
    v_accvgpr_write_b32 a179, v33
    v_accvgpr_read_b32 v30, a192
    v_accvgpr_read_b32 v31, a193
    v_accvgpr_read_b32 v32, a194
    v_accvgpr_read_b32 v33, a195
    v_mul_f32 v30, v30, v39
    v_mul_f32 v31, v31, v39
    v_mul_f32 v32, v32, v39
    v_mul_f32 v33, v33, v39
    v_accvgpr_write_b32 a192, v30
    v_accvgpr_write_b32 a193, v31
    v_accvgpr_write_b32 a194, v32
    v_accvgpr_write_b32 a195, v33
    v_accvgpr_read_b32 v30, a208
    v_accvgpr_read_b32 v31, a209
    v_accvgpr_read_b32 v32, a210
    v_accvgpr_read_b32 v33, a211
    v_mul_f32 v30, v30, v39
    v_mul_f32 v31, v31, v39
    v_mul_f32 v32, v32, v39
    v_mul_f32 v33, v33, v39
    v_accvgpr_write_b32 a208, v30
    v_accvgpr_write_b32 a209, v31
    v_accvgpr_write_b32 a210, v32
    v_accvgpr_write_b32 a211, v33
    v_exp_f32 v30, v80
    s_nop 0
    v_exp_f32 v31, v81
    s_nop 0
    v_exp_f32 v32, v82
    s_nop 0
    v_add_f32 v28, v30, v31
    v_cvt_pk_bf16_f32 v56, v30, v31
    v_exp_f32 v33, v83
    s_nop 0
    v_add_f32 v28, v28, v32
    v_exp_f32 v30, v84
    s_nop 0
    v_add_f32 v28, v28, v33
    v_cvt_pk_bf16_f32 v57, v32, v33
    v_exp_f32 v31, v85
    s_nop 0
    v_add_f32 v28, v28, v30
    v_exp_f32 v32, v86
    s_nop 0
    v_add_f32 v28, v28, v31
    v_cvt_pk_bf16_f32 v58, v30, v31
    v_exp_f32 v33, v87
    s_nop 0
    v_add_f32 v28, v28, v32
    v_add_f32 v28, v28, v33
    v_cvt_pk_bf16_f32 v59, v32, v33
    v_max3_f32 v30, v88, v89, v90
    v_max3_f32 v30, v30, v91, v92
    v_max3_f32 v30, v30, v93, v94
    v_max_f32 v30, v30, v95
    v_mov_b32 v31, v30
    s_nop 1
    v_permlane32_swap_b32 v31, v30
    v_max_f32 v30, v30, v31
    v_mov_b32 v31, v30
    s_nop 1
    v_permlane16_swap_b32 v31, v30
    v_max_f32 v30, v30, v31
    v_max_f32 v30, 0, v30
    v_sub_f32 v88, v88, v30
    v_sub_f32 v89, v89, v30
    v_sub_f32 v90, v90, v30
    v_sub_f32 v91, v91, v30
    v_sub_f32 v92, v92, v30
    v_sub_f32 v93, v93, v30
    v_sub_f32 v94, v94, v30
    v_sub_f32 v95, v95, v30
    v_add_f32 v21, v21, v30
    v_exp_f32 v39, -v30
    s_nop 0
    v_mul_f32 v25, v25, v39
    v_mul_f32 v140, v140, v39
    v_mul_f32 v141, v141, v39
    v_mul_f32 v142, v142, v39
    v_mul_f32 v143, v143, v39
    v_mul_f32 v156, v156, v39
    v_mul_f32 v157, v157, v39
    v_mul_f32 v158, v158, v39
    v_mul_f32 v159, v159, v39
    v_mul_f32 v172, v172, v39
    v_mul_f32 v173, v173, v39
    v_mul_f32 v174, v174, v39
    v_mul_f32 v175, v175, v39
    v_mul_f32 v188, v188, v39
    v_mul_f32 v189, v189, v39
    v_mul_f32 v190, v190, v39
    v_mul_f32 v191, v191, v39
    v_mul_f32 v204, v204, v39
    v_mul_f32 v205, v205, v39
    v_mul_f32 v206, v206, v39
    v_mul_f32 v207, v207, v39
    v_mul_f32 v220, v220, v39
    v_mul_f32 v221, v221, v39
    v_mul_f32 v222, v222, v39
    v_mul_f32 v223, v223, v39
    v_mul_f32 v236, v236, v39
    v_mul_f32 v237, v237, v39
    v_mul_f32 v238, v238, v39
    v_mul_f32 v239, v239, v39
    v_mul_f32 v252, v252, v39
    v_mul_f32 v253, v253, v39
    v_mul_f32 v254, v254, v39
    v_mul_f32 v255, v255, v39
    v_accvgpr_read_b32 v30, a164
    v_accvgpr_read_b32 v31, a165
    v_accvgpr_read_b32 v32, a166
    v_accvgpr_read_b32 v33, a167
    v_mul_f32 v30, v30, v39
    v_mul_f32 v31, v31, v39
    v_mul_f32 v32, v32, v39
    v_mul_f32 v33, v33, v39
    v_accvgpr_write_b32 a164, v30
    v_accvgpr_write_b32 a165, v31
    v_accvgpr_write_b32 a166, v32
    v_accvgpr_write_b32 a167, v33
    v_accvgpr_read_b32 v30, a180
    v_accvgpr_read_b32 v31, a181
    v_accvgpr_read_b32 v32, a182
    v_accvgpr_read_b32 v33, a183
    v_mul_f32 v30, v30, v39
    v_mul_f32 v31, v31, v39
    v_mul_f32 v32, v32, v39
    v_mul_f32 v33, v33, v39
    v_accvgpr_write_b32 a180, v30
    v_accvgpr_write_b32 a181, v31
    v_accvgpr_write_b32 a182, v32
    v_accvgpr_write_b32 a183, v33
    v_accvgpr_read_b32 v30, a196
    v_accvgpr_read_b32 v31, a197
    v_accvgpr_read_b32 v32, a198
    v_accvgpr_read_b32 v33, a199
    v_mul_f32 v30, v30, v39
    v_mul_f32 v31, v31, v39
    v_mul_f32 v32, v32, v39
    v_mul_f32 v33, v33, v39
    v_accvgpr_write_b32 a196, v30
    v_accvgpr_write_b32 a197, v31
    v_accvgpr_write_b32 a198, v32
    v_accvgpr_write_b32 a199, v33
    v_accvgpr_read_b32 v30, a212
    v_accvgpr_read_b32 v31, a213
    v_accvgpr_read_b32 v32, a214
    v_accvgpr_read_b32 v33, a215
    v_mul_f32 v30, v30, v39
    v_mul_f32 v31, v31, v39
    v_mul_f32 v32, v32, v39
    v_mul_f32 v33, v33, v39
    v_accvgpr_write_b32 a212, v30
    v_accvgpr_write_b32 a213, v31
    v_accvgpr_write_b32 a214, v32
    v_accvgpr_write_b32 a215, v33
    v_exp_f32 v30, v88
    s_nop 0
    v_exp_f32 v31, v89
    s_nop 0
    v_exp_f32 v32, v90
    s_nop 0
    v_add_f32 v29, v30, v31
    v_cvt_pk_bf16_f32 v60, v30, v31
    v_exp_f32 v33, v91
    s_nop 0
    v_add_f32 v29, v29, v32
    v_exp_f32 v30, v92
    s_nop 0
    v_add_f32 v29, v29, v33
    v_cvt_pk_bf16_f32 v61, v32, v33
    v_exp_f32 v31, v93
    s_nop 0
    v_add_f32 v29, v29, v30
    v_exp_f32 v32, v94
    s_nop 0
    v_add_f32 v29, v29, v31
    v_cvt_pk_bf16_f32 v62, v30, v31
    v_exp_f32 v33, v95
    s_nop 0
    v_add_f32 v29, v29, v32
    v_add_f32 v29, v29, v33
    v_cvt_pk_bf16_f32 v63, v32, v33
    s_nop 1
    s_setpc_b64 s[32:33]
Lfix31_0:
    s_nop 7
    v_max3_f32 v30, v96, v97, v98
    v_max3_f32 v30, v30, v99, v100
    v_max3_f32 v30, v30, v101, v102
    v_max_f32 v30, v30, v103
    v_mov_b32 v31, v30
    s_nop 1
    v_permlane32_swap_b32 v31, v30
    v_max_f32 v30, v30, v31
    v_mov_b32 v31, v30
    s_nop 1
    v_permlane16_swap_b32 v31, v30
    v_max_f32 v30, v30, v31
    v_max_f32 v30, 0, v30
    v_sub_f32 v96, v96, v30
    v_sub_f32 v97, v97, v30
    v_sub_f32 v98, v98, v30
    v_sub_f32 v99, v99, v30
    v_sub_f32 v100, v100, v30
    v_sub_f32 v101, v101, v30
    v_sub_f32 v102, v102, v30
    v_sub_f32 v103, v103, v30
    v_add_f32 v18, v18, v30
    v_exp_f32 v39, -v30
    s_nop 0
    v_mul_f32 v22, v22, v39
    v_mul_f32 v128, v128, v39
    v_mul_f32 v129, v129, v39
    v_mul_f32 v130, v130, v39
    v_mul_f32 v131, v131, v39
    v_mul_f32 v144, v144, v39
    v_mul_f32 v145, v145, v39
    v_mul_f32 v146, v146, v39
    v_mul_f32 v147, v147, v39
    v_mul_f32 v160, v160, v39
    v_mul_f32 v161, v161, v39
    v_mul_f32 v162, v162, v39
    v_mul_f32 v163, v163, v39
    v_mul_f32 v176, v176, v39
    v_mul_f32 v177, v177, v39
    v_mul_f32 v178, v178, v39
    v_mul_f32 v179, v179, v39
    v_mul_f32 v192, v192, v39
    v_mul_f32 v193, v193, v39
    v_mul_f32 v194, v194, v39
    v_mul_f32 v195, v195, v39
    v_mul_f32 v208, v208, v39
    v_mul_f32 v209, v209, v39
    v_mul_f32 v210, v210, v39
    v_mul_f32 v211, v211, v39
    v_mul_f32 v224, v224, v39
    v_mul_f32 v225, v225, v39
    v_mul_f32 v226, v226, v39
    v_mul_f32 v227, v227, v39
    v_mul_f32 v240, v240, v39
    v_mul_f32 v241, v241, v39
    v_mul_f32 v242, v242, v39
    v_mul_f32 v243, v243, v39
    v_accvgpr_read_b32 v30, a152
    v_accvgpr_read_b32 v31, a153
    v_accvgpr_read_b32 v32, a154
    v_accvgpr_read_b32 v33, a155
    v_mul_f32 v30, v30, v39
    v_mul_f32 v31, v31, v39
    v_mul_f32 v32, v32, v39
    v_mul_f32 v33, v33, v39
    v_accvgpr_write_b32 a152, v30
    v_accvgpr_write_b32 a153, v31
    v_accvgpr_write_b32 a154, v32
    v_accvgpr_write_b32 a155, v33
    v_accvgpr_read_b32 v30, a168
    v_accvgpr_read_b32 v31, a169
    v_accvgpr_read_b32 v32, a170
    v_accvgpr_read_b32 v33, a171
    v_mul_f32 v30, v30, v39
    v_mul_f32 v31, v31, v39
    v_mul_f32 v32, v32, v39
    v_mul_f32 v33, v33, v39
    v_accvgpr_write_b32 a168, v30
    v_accvgpr_write_b32 a169, v31
    v_accvgpr_write_b32 a170, v32
    v_accvgpr_write_b32 a171, v33
    v_accvgpr_read_b32 v30, a184
    v_accvgpr_read_b32 v31, a185
    v_accvgpr_read_b32 v32, a186
    v_accvgpr_read_b32 v33, a187
    v_mul_f32 v30, v30, v39
    v_mul_f32 v31, v31, v39
    v_mul_f32 v32, v32, v39
    v_mul_f32 v33, v33, v39
    v_accvgpr_write_b32 a184, v30
    v_accvgpr_write_b32 a185, v31
    v_accvgpr_write_b32 a186, v32
    v_accvgpr_write_b32 a187, v33
    v_accvgpr_read_b32 v30, a200
    v_accvgpr_read_b32 v31, a201
    v_accvgpr_read_b32 v32, a202
    v_accvgpr_read_b32 v33, a203
    v_mul_f32 v30, v30, v39
    v_mul_f32 v31, v31, v39
    v_mul_f32 v32, v32, v39
    v_mul_f32 v33, v33, v39
    v_accvgpr_write_b32 a200, v30
    v_accvgpr_write_b32 a201, v31
    v_accvgpr_write_b32 a202, v32
    v_accvgpr_write_b32 a203, v33
    v_exp_f32 v30, v96
    s_nop 0
    v_exp_f32 v31, v97
    s_nop 0
    v_exp_f32 v32, v98
    s_nop 0
    v_add_f32 v26, v30, v31
    v_cvt_pk_bf16_f32 v48, v30, v31
    v_exp_f32 v33, v99
    s_nop 0
    v_add_f32 v26, v26, v32
    v_exp_f32 v30, v100
    s_nop 0
    v_add_f32 v26, v26, v33
    v_cvt_pk_bf16_f32 v49, v32, v33
    v_exp_f32 v31, v101
    s_nop 0
    v_add_f32 v26, v26, v30
    v_exp_f32 v32, v102
    s_nop 0
    v_add_f32 v26, v26, v31
    v_cvt_pk_bf16_f32 v50, v30, v31
    v_exp_f32 v33, v103
    s_nop 0
    v_add_f32 v26, v26, v32
    v_add_f32 v26, v26, v33
    v_cvt_pk_bf16_f32 v51, v32, v33
    s_nop 1
    s_setpc_b64 s[32:33]
Lfix31_1:
    s_nop 7
    v_max3_f32 v30, v104, v105, v106
    v_max3_f32 v30, v30, v107, v108
    v_max3_f32 v30, v30, v109, v110
    v_max_f32 v30, v30, v111
    v_mov_b32 v31, v30
    s_nop 1
    v_permlane32_swap_b32 v31, v30
    v_max_f32 v30, v30, v31
    v_mov_b32 v31, v30
    s_nop 1
    v_permlane16_swap_b32 v31, v30
    v_max_f32 v30, v30, v31
    v_max_f32 v30, 0, v30
    v_sub_f32 v104, v104, v30
    v_sub_f32 v105, v105, v30
    v_sub_f32 v106, v106, v30
    v_sub_f32 v107, v107, v30
    v_sub_f32 v108, v108, v30
    v_sub_f32 v109, v109, v30
    v_sub_f32 v110, v110, v30
    v_sub_f32 v111, v111, v30
    v_add_f32 v19, v19, v30
    v_exp_f32 v39, -v30
    s_nop 0
    v_mul_f32 v23, v23, v39
    v_mul_f32 v132, v132, v39
    v_mul_f32 v133, v133, v39
    v_mul_f32 v134, v134, v39
    v_mul_f32 v135, v135, v39
    v_mul_f32 v148, v148, v39
    v_mul_f32 v149, v149, v39
    v_mul_f32 v150, v150, v39
    v_mul_f32 v151, v151, v39
    v_mul_f32 v164, v164, v39
    v_mul_f32 v165, v165, v39
    v_mul_f32 v166, v166, v39
    v_mul_f32 v167, v167, v39
    v_mul_f32 v180, v180, v39
    v_mul_f32 v181, v181, v39
    v_mul_f32 v182, v182, v39
    v_mul_f32 v183, v183, v39
    v_mul_f32 v196, v196, v39
    v_mul_f32 v197, v197, v39
    v_mul_f32 v198, v198, v39
    v_mul_f32 v199, v199, v39
    v_mul_f32 v212, v212, v39
    v_mul_f32 v213, v213, v39
    v_mul_f32 v214, v214, v39
    v_mul_f32 v215, v215, v39
    v_mul_f32 v228, v228, v39
    v_mul_f32 v229, v229, v39
    v_mul_f32 v230, v230, v39
    v_mul_f32 v231, v231, v39
    v_mul_f32 v244, v244, v39
    v_mul_f32 v245, v245, v39
    v_mul_f32 v246, v246, v39
    v_mul_f32 v247, v247, v39
    v_accvgpr_read_b32 v30, a156
    v_accvgpr_read_b32 v31, a157
    v_accvgpr_read_b32 v32, a158
    v_accvgpr_read_b32 v33, a159
    v_mul_f32 v30, v30, v39
    v_mul_f32 v31, v31, v39
    v_mul_f32 v32, v32, v39
    v_mul_f32 v33, v33, v39
    v_accvgpr_write_b32 a156, v30
    v_accvgpr_write_b32 a157, v31
    v_accvgpr_write_b32 a158, v32
    v_accvgpr_write_b32 a159, v33
    v_accvgpr_read_b32 v30, a172
    v_accvgpr_read_b32 v31, a173
    v_accvgpr_read_b32 v32, a174
    v_accvgpr_read_b32 v33, a175
    v_mul_f32 v30, v30, v39
    v_mul_f32 v31, v31, v39
    v_mul_f32 v32, v32, v39
    v_mul_f32 v33, v33, v39
    v_accvgpr_write_b32 a172, v30
    v_accvgpr_write_b32 a173, v31
    v_accvgpr_write_b32 a174, v32
    v_accvgpr_write_b32 a175, v33
    v_accvgpr_read_b32 v30, a188
    v_accvgpr_read_b32 v31, a189
    v_accvgpr_read_b32 v32, a190
    v_accvgpr_read_b32 v33, a191
    v_mul_f32 v30, v30, v39
    v_mul_f32 v31, v31, v39
    v_mul_f32 v32, v32, v39
    v_mul_f32 v33, v33, v39
    v_accvgpr_write_b32 a188, v30
    v_accvgpr_write_b32 a189, v31
    v_accvgpr_write_b32 a190, v32
    v_accvgpr_write_b32 a191, v33
    v_accvgpr_read_b32 v30, a204
    v_accvgpr_read_b32 v31, a205
    v_accvgpr_read_b32 v32, a206
    v_accvgpr_read_b32 v33, a207
    v_mul_f32 v30, v30, v39
    v_mul_f32 v31, v31, v39
    v_mul_f32 v32, v32, v39
    v_mul_f32 v33, v33, v39
    v_accvgpr_write_b32 a204, v30
    v_accvgpr_write_b32 a205, v31
    v_accvgpr_write_b32 a206, v32
    v_accvgpr_write_b32 a207, v33
    v_exp_f32 v30, v104
    s_nop 0
    v_exp_f32 v31, v105
    s_nop 0
    v_exp_f32 v32, v106
    s_nop 0
    v_add_f32 v27, v30, v31
    v_cvt_pk_bf16_f32 v52, v30, v31
    v_exp_f32 v33, v107
    s_nop 0
    v_add_f32 v27, v27, v32
    v_exp_f32 v30, v108
    s_nop 0
    v_add_f32 v27, v27, v33
    v_cvt_pk_bf16_f32 v53, v32, v33
    v_exp_f32 v31, v109
    s_nop 0
    v_add_f32 v27, v27, v30
    v_exp_f32 v32, v110
    s_nop 0
    v_add_f32 v27, v27, v31
    v_cvt_pk_bf16_f32 v54, v30, v31
    v_exp_f32 v33, v111
    s_nop 0
    v_add_f32 v27, v27, v32
    v_add_f32 v27, v27, v33
    v_cvt_pk_bf16_f32 v55, v32, v33
    s_nop 1
    s_setpc_b64 s[32:33]
Lfix31_2:
    s_nop 7
    v_max3_f32 v30, v112, v113, v114
    v_max3_f32 v30, v30, v115, v116
    v_max3_f32 v30, v30, v117, v118
    v_max_f32 v30, v30, v119
    v_mov_b32 v31, v30
    s_nop 1
    v_permlane32_swap_b32 v31, v30
    v_max_f32 v30, v30, v31
    v_mov_b32 v31, v30
    s_nop 1
    v_permlane16_swap_b32 v31, v30
    v_max_f32 v30, v30, v31
    v_max_f32 v30, 0, v30
    v_sub_f32 v112, v112, v30
    v_sub_f32 v113, v113, v30
    v_sub_f32 v114, v114, v30
    v_sub_f32 v115, v115, v30
    v_sub_f32 v116, v116, v30
    v_sub_f32 v117, v117, v30
    v_sub_f32 v118, v118, v30
    v_sub_f32 v119, v119, v30
    v_add_f32 v20, v20, v30
    v_exp_f32 v39, -v30
    s_nop 0
    v_mul_f32 v24, v24, v39
    v_mul_f32 v136, v136, v39
    v_mul_f32 v137, v137, v39
    v_mul_f32 v138, v138, v39
    v_mul_f32 v139, v139, v39
    v_mul_f32 v152, v152, v39
    v_mul_f32 v153, v153, v39
    v_mul_f32 v154, v154, v39
    v_mul_f32 v155, v155, v39
    v_mul_f32 v168, v168, v39
    v_mul_f32 v169, v169, v39
    v_mul_f32 v170, v170, v39
    v_mul_f32 v171, v171, v39
    v_mul_f32 v184, v184, v39
    v_mul_f32 v185, v185, v39
    v_mul_f32 v186, v186, v39
    v_mul_f32 v187, v187, v39
    v_mul_f32 v200, v200, v39
    v_mul_f32 v201, v201, v39
    v_mul_f32 v202, v202, v39
    v_mul_f32 v203, v203, v39
    v_mul_f32 v216, v216, v39
    v_mul_f32 v217, v217, v39
    v_mul_f32 v218, v218, v39
    v_mul_f32 v219, v219, v39
    v_mul_f32 v232, v232, v39
    v_mul_f32 v233, v233, v39
    v_mul_f32 v234, v234, v39
    v_mul_f32 v235, v235, v39
    v_mul_f32 v248, v248, v39
    v_mul_f32 v249, v249, v39
    v_mul_f32 v250, v250, v39
    v_mul_f32 v251, v251, v39
    v_accvgpr_read_b32 v30, a160
    v_accvgpr_read_b32 v31, a161
    v_accvgpr_read_b32 v32, a162
    v_accvgpr_read_b32 v33, a163
    v_mul_f32 v30, v30, v39
    v_mul_f32 v31, v31, v39
    v_mul_f32 v32, v32, v39
    v_mul_f32 v33, v33, v39
    v_accvgpr_write_b32 a160, v30
    v_accvgpr_write_b32 a161, v31
    v_accvgpr_write_b32 a162, v32
    v_accvgpr_write_b32 a163, v33
    v_accvgpr_read_b32 v30, a176
    v_accvgpr_read_b32 v31, a177
    v_accvgpr_read_b32 v32, a178
    v_accvgpr_read_b32 v33, a179
    v_mul_f32 v30, v30, v39
    v_mul_f32 v31, v31, v39
    v_mul_f32 v32, v32, v39
    v_mul_f32 v33, v33, v39
    v_accvgpr_write_b32 a176, v30
    v_accvgpr_write_b32 a177, v31
    v_accvgpr_write_b32 a178, v32
    v_accvgpr_write_b32 a179, v33
    v_accvgpr_read_b32 v30, a192
    v_accvgpr_read_b32 v31, a193
    v_accvgpr_read_b32 v32, a194
    v_accvgpr_read_b32 v33, a195
    v_mul_f32 v30, v30, v39
    v_mul_f32 v31, v31, v39
    v_mul_f32 v32, v32, v39
    v_mul_f32 v33, v33, v39
    v_accvgpr_write_b32 a192, v30
    v_accvgpr_write_b32 a193, v31
    v_accvgpr_write_b32 a194, v32
    v_accvgpr_write_b32 a195, v33
    v_accvgpr_read_b32 v30, a208
    v_accvgpr_read_b32 v31, a209
    v_accvgpr_read_b32 v32, a210
    v_accvgpr_read_b32 v33, a211
    v_mul_f32 v30, v30, v39
    v_mul_f32 v31, v31, v39
    v_mul_f32 v32, v32, v39
    v_mul_f32 v33, v33, v39
    v_accvgpr_write_b32 a208, v30
    v_accvgpr_write_b32 a209, v31
    v_accvgpr_write_b32 a210, v32
    v_accvgpr_write_b32 a211, v33
    v_exp_f32 v30, v112
    s_nop 0
    v_exp_f32 v31, v113
    s_nop 0
    v_exp_f32 v32, v114
    s_nop 0
    v_add_f32 v28, v30, v31
    v_cvt_pk_bf16_f32 v64, v30, v31
    v_exp_f32 v33, v115
    s_nop 0
    v_add_f32 v28, v28, v32
    v_exp_f32 v30, v116
    s_nop 0
    v_add_f32 v28, v28, v33
    v_cvt_pk_bf16_f32 v65, v32, v33
    v_exp_f32 v31, v117
    s_nop 0
    v_add_f32 v28, v28, v30
    v_exp_f32 v32, v118
    s_nop 0
    v_add_f32 v28, v28, v31
    v_cvt_pk_bf16_f32 v66, v30, v31
    v_exp_f32 v33, v119
    s_nop 0
    v_add_f32 v28, v28, v32
    v_add_f32 v28, v28, v33
    v_cvt_pk_bf16_f32 v67, v32, v33
    s_nop 1
    s_setpc_b64 s[32:33]
Lfix31_3:
    s_nop 7
    v_max3_f32 v30, v120, v121, v122
    v_max3_f32 v30, v30, v123, v124
    v_max3_f32 v30, v30, v125, v126
    v_max_f32 v30, v30, v127
    v_mov_b32 v31, v30
    s_nop 1
    v_permlane32_swap_b32 v31, v30
    v_max_f32 v30, v30, v31
    v_mov_b32 v31, v30
    s_nop 1
    v_permlane16_swap_b32 v31, v30
    v_max_f32 v30, v30, v31
    v_max_f32 v30, 0, v30
    v_sub_f32 v120, v120, v30
    v_sub_f32 v121, v121, v30
    v_sub_f32 v122, v122, v30
    v_sub_f32 v123, v123, v30
    v_sub_f32 v124, v124, v30
    v_sub_f32 v125, v125, v30
    v_sub_f32 v126, v126, v30
    v_sub_f32 v127, v127, v30
    v_add_f32 v21, v21, v30
    v_exp_f32 v39, -v30
    s_nop 0
    v_mul_f32 v25, v25, v39
    v_mul_f32 v140, v140, v39
    v_mul_f32 v141, v141, v39
    v_mul_f32 v142, v142, v39
    v_mul_f32 v143, v143, v39
    v_mul_f32 v156, v156, v39
    v_mul_f32 v157, v157, v39
    v_mul_f32 v158, v158, v39
    v_mul_f32 v159, v159, v39
    v_mul_f32 v172, v172, v39
    v_mul_f32 v173, v173, v39
    v_mul_f32 v174, v174, v39
    v_mul_f32 v175, v175, v39
    v_mul_f32 v188, v188, v39
    v_mul_f32 v189, v189, v39
    v_mul_f32 v190, v190, v39
    v_mul_f32 v191, v191, v39
    v_mul_f32 v204, v204, v39
    v_mul_f32 v205, v205, v39
    v_mul_f32 v206, v206, v39
    v_mul_f32 v207, v207, v39
    v_mul_f32 v220, v220, v39
    v_mul_f32 v221, v221, v39
    v_mul_f32 v222, v222, v39
    v_mul_f32 v223, v223, v39
    v_mul_f32 v236, v236, v39
    v_mul_f32 v237, v237, v39
    v_mul_f32 v238, v238, v39
    v_mul_f32 v239, v239, v39
    v_mul_f32 v252, v252, v39
    v_mul_f32 v253, v253, v39
    v_mul_f32 v254, v254, v39
    v_mul_f32 v255, v255, v39
    v_accvgpr_read_b32 v30, a164
    v_accvgpr_read_b32 v31, a165
    v_accvgpr_read_b32 v32, a166
    v_accvgpr_read_b32 v33, a167
    v_mul_f32 v30, v30, v39
    v_mul_f32 v31, v31, v39
    v_mul_f32 v32, v32, v39
    v_mul_f32 v33, v33, v39
    v_accvgpr_write_b32 a164, v30
    v_accvgpr_write_b32 a165, v31
    v_accvgpr_write_b32 a166, v32
    v_accvgpr_write_b32 a167, v33
    v_accvgpr_read_b32 v30, a180
    v_accvgpr_read_b32 v31, a181
    v_accvgpr_read_b32 v32, a182
    v_accvgpr_read_b32 v33, a183
    v_mul_f32 v30, v30, v39
    v_mul_f32 v31, v31, v39
    v_mul_f32 v32, v32, v39
    v_mul_f32 v33, v33, v39
    v_accvgpr_write_b32 a180, v30
    v_accvgpr_write_b32 a181, v31
    v_accvgpr_write_b32 a182, v32
    v_accvgpr_write_b32 a183, v33
    v_accvgpr_read_b32 v30, a196
    v_accvgpr_read_b32 v31, a197
    v_accvgpr_read_b32 v32, a198
    v_accvgpr_read_b32 v33, a199
    v_mul_f32 v30, v30, v39
    v_mul_f32 v31, v31, v39
    v_mul_f32 v32, v32, v39
    v_mul_f32 v33, v33, v39
    v_accvgpr_write_b32 a196, v30
    v_accvgpr_write_b32 a197, v31
    v_accvgpr_write_b32 a198, v32
    v_accvgpr_write_b32 a199, v33
    v_accvgpr_read_b32 v30, a212
    v_accvgpr_read_b32 v31, a213
    v_accvgpr_read_b32 v32, a214
    v_accvgpr_read_b32 v33, a215
    v_mul_f32 v30, v30, v39
    v_mul_f32 v31, v31, v39
    v_mul_f32 v32, v32, v39
    v_mul_f32 v33, v33, v39
    v_accvgpr_write_b32 a212, v30
    v_accvgpr_write_b32 a213, v31
    v_accvgpr_write_b32 a214, v32
    v_accvgpr_write_b32 a215, v33
    v_exp_f32 v30, v120
    s_nop 0
    v_exp_f32 v31, v121
    s_nop 0
    v_exp_f32 v32, v122
    s_nop 0
    v_add_f32 v29, v30, v31
    v_cvt_pk_bf16_f32 v68, v30, v31
    v_exp_f32 v33, v123
    s_nop 0
    v_add_f32 v29, v29, v32
    v_exp_f32 v30, v124
    s_nop 0
    v_add_f32 v29, v29, v33
    v_cvt_pk_bf16_f32 v69, v32, v33
    v_exp_f32 v31, v125
    s_nop 0
    v_add_f32 v29, v29, v30
    v_exp_f32 v32, v126
    s_nop 0
    v_add_f32 v29, v29, v31
    v_cvt_pk_bf16_f32 v70, v30, v31
    v_exp_f32 v33, v127
    s_nop 0
    v_add_f32 v29, v29, v32
    v_add_f32 v29, v29, v33
    v_cvt_pk_bf16_f32 v71, v32, v33
    s_nop 1
    s_setpc_b64 s[32:33]
.section .rodata,"a"
.p2align 6
.amdhsa_kernel standalone__mha_softmax__near_ridge_kernel
  .amdhsa_next_free_vgpr 512
  .amdhsa_next_free_sgpr 102
  .amdhsa_accum_offset 256
  .amdhsa_group_segment_fixed_size 0
  .amdhsa_kernarg_size 48
  .amdhsa_user_sgpr_count 2
  .amdhsa_user_sgpr_kernarg_segment_ptr 1
  .amdhsa_system_sgpr_workgroup_id_x 1
.end_amdhsa_kernel
```
